```python
import torch

def _softmax(x, axis=-1):
    return torch.softmax(x, dim=axis)
def _gelu(x):
    return torch.nn.functional.gelu(x, approximate="tanh")
def _silu(x):
    return torch.nn.functional.silu(x)
def _sigmoid(x):
    return torch.sigmoid(x)
def _layernorm(x, axis=-1, eps=1e-5):
    m = x.mean(dim=axis, keepdim=True)
    v = x.var(dim=axis, keepdim=True, unbiased=False)
    return (x - m) / torch.sqrt(v + eps)
def _scatter_add(tgt, idx, src, axis=0):
    return tgt.clone().index_add_(axis, idx, src)
def _segment_sum(src, seg, n):
    out = torch.zeros((n,) + src.shape[1:], dtype=src.dtype)
    return out.index_add_(0, seg, src)
def _pad(x, pw):
    flat = tuple(v for pair in reversed(pw) for v in pair)
    return torch.nn.functional.pad(x, flat)

kernel_name = 'concat_heads__ssm_conv_s5__ssm_conv_s5__prompt'

def setup_inputs():

    _w = (lambda a: (lambda t: t.to(torch.bfloat16) if t.is_floating_point() else t)(torch.as_tensor(a)))
    def _A_setup():
        B, S, D = 1, 2048, 576
        P = D
        Lambda_re = -0.5 * (lambda _x: torch.exp(torch.as_tensor(_x)))((lambda *s: torch.randn(*s, dtype=torch.bfloat16) * 0.2)(P))
        Lambda_im = (lambda *s: torch.randn(*s, dtype=torch.bfloat16) * 0.4)(P) * 1.0
        B_re = (lambda *s: torch.randn(*s, dtype=torch.bfloat16) * 0.2)(P, D) * (D ** -0.5)
        B_im = (lambda *s: torch.randn(*s, dtype=torch.bfloat16) * 0.2)(P, D) * (D ** -0.5)
        C_re = (lambda *s: torch.randn(*s, dtype=torch.bfloat16) * 0.2)(D, P) * (P ** -0.5)
        C_im = (lambda *s: torch.randn(*s, dtype=torch.bfloat16) * 0.2)(D, P) * (P ** -0.5)
        log_dt = (lambda *s: torch.randn(*s, dtype=torch.bfloat16) * 0.2)(P) * 0.3 - 2.0
        Dskip = (lambda *s: torch.randn(*s, dtype=torch.bfloat16) * 0.05)(D)
        return {
            "x": _w((lambda *s: torch.randn(*s, dtype=torch.bfloat16) * 0.05)(B, S, D)),
            "Lambda_re": _w(Lambda_re),
            "Lambda_im": _w(Lambda_im),
            "B_re": _w(B_re),
            "B_im": _w(B_im),
            "C_re": _w(C_re),
            "C_im": _w(C_im),
            "log_dt": _w(log_dt),
            "Dskip": _w(Dskip),
        }
    _A_in = _A_setup()

    def _B_setup():
        B, S, D = 1, 2048, 576
        P = D
        Lambda_re = -0.5 * (lambda _x: torch.exp(torch.as_tensor(_x)))((lambda *s: torch.randn(*s, dtype=torch.bfloat16) * 0.2)(P))
        Lambda_im = (lambda *s: torch.randn(*s, dtype=torch.bfloat16) * 0.4)(P) * 1.0
        B_re = (lambda *s: torch.randn(*s, dtype=torch.bfloat16) * 0.2)(P, D) * (D ** -0.5)
        B_im = (lambda *s: torch.randn(*s, dtype=torch.bfloat16) * 0.2)(P, D) * (D ** -0.5)
        C_re = (lambda *s: torch.randn(*s, dtype=torch.bfloat16) * 0.2)(D, P) * (P ** -0.5)
        C_im = (lambda *s: torch.randn(*s, dtype=torch.bfloat16) * 0.2)(D, P) * (P ** -0.5)
        log_dt = (lambda *s: torch.randn(*s, dtype=torch.bfloat16) * 0.2)(P) * 0.3 - 2.0
        Dskip = (lambda *s: torch.randn(*s, dtype=torch.bfloat16) * 0.05)(D)
        return {
            "x": _w((lambda *s: torch.randn(*s, dtype=torch.bfloat16) * 0.05)(B, S, D)),
            "Lambda_re": _w(Lambda_re),
            "Lambda_im": _w(Lambda_im),
            "B_re": _w(B_re),
            "B_im": _w(B_im),
            "C_re": _w(C_re),
            "C_im": _w(C_im),
            "log_dt": _w(log_dt),
            "Dskip": _w(Dskip),
        }
    _B_in = _B_setup()

    return {
        "A_x": _A_in["x"],
        "A_Lambda_re": _A_in["Lambda_re"],
        "A_Lambda_im": _A_in["Lambda_im"],
        "A_B_re": _A_in["B_re"],
        "A_B_im": _A_in["B_im"],
        "A_C_re": _A_in["C_re"],
        "A_C_im": _A_in["C_im"],
        "A_log_dt": _A_in["log_dt"],
        "A_Dskip": _A_in["Dskip"],
        "B_x": _B_in["x"],
        "B_Lambda_re": _B_in["Lambda_re"],
        "B_Lambda_im": _B_in["Lambda_im"],
        "B_B_re": _B_in["B_re"],
        "B_B_im": _B_in["B_im"],
        "B_C_re": _B_in["C_re"],
        "B_C_im": _B_in["C_im"],
        "B_log_dt": _B_in["log_dt"],
        "B_Dskip": _B_in["Dskip"],
    }

def reference(A_x, A_Lambda_re, A_Lambda_im, A_B_re, A_B_im, A_C_re, A_C_im, A_log_dt, A_Dskip, B_x, B_Lambda_re, B_Lambda_im, B_B_re, B_B_im, B_C_re, B_C_im, B_log_dt, B_Dskip):
    def _A_ref(x, Lambda_re, Lambda_im, B_re, B_im, C_re, C_im, log_dt, Dskip):
        Bsz, L, H = x.shape
        Lam = Lambda_re + 1j * Lambda_im
        Bmat = B_re + 1j * B_im
        Cmat = C_re + 1j * C_im
        dt = torch.exp(log_dt)
        Lam_bar = torch.exp(dt * Lam)
        B_bar = ((Lam_bar - 1.0) / Lam)[:, None] * Bmat
        Bu = torch.einsum("bld,pd->blp", x + 0j, B_bar)
        h = torch.zeros_like(Bu[:, 0, :])
        hs = []
        for t in range(L):
            h = Lam_bar[None, :] * h + Bu[:, t, :]
            hs.append(h)
        hseq = torch.stack(hs, 1)
        y = 2.0 * torch.einsum("blp,dp->bld", hseq, Cmat).real + x * Dskip[None, None, :]
        return y

    def _B_ref(x, Lambda_re, Lambda_im, B_re, B_im, C_re, C_im, log_dt, Dskip):
        Bsz, L, H = x.shape
        Lam = Lambda_re + 1j * Lambda_im
        Bmat = B_re + 1j * B_im
        Cmat = C_re + 1j * C_im
        dt = torch.exp(log_dt)
        Lam_bar = torch.exp(dt * Lam)
        B_bar = ((Lam_bar - 1.0) / Lam)[:, None] * Bmat
        Bu = torch.einsum("bld,pd->blp", x + 0j, B_bar)
        h = torch.zeros_like(Bu[:, 0, :])
        hs = []
        for t in range(L):
            h = Lam_bar[None, :] * h + Bu[:, t, :]
            hs.append(h)
        hseq = torch.stack(hs, 1)
        y = 2.0 * torch.einsum("blp,dp->bld", hseq, Cmat).real + x * Dskip[None, None, :]
        return y

    a = _A_ref(A_x, A_Lambda_re, A_Lambda_im, A_B_re, A_B_im, A_C_re, A_C_im, A_log_dt, A_Dskip)
    b = _B_ref(B_x, B_Lambda_re, B_Lambda_im, B_B_re, B_B_im, B_C_re, B_C_im, B_log_dt, B_Dskip)
    return torch.concatenate([a, b], axis=-1)
```

```asm
; @launch grid=(256,1,1) block=(512,1,1) lds=163840
.amdgcn_target "amdgcn-amd-amdhsa--gfx950"
.text
.globl concat_heads__ssm_conv_s5__ssm_conv_s5__prompt_kernel
.p2align 8
.type concat_heads__ssm_conv_s5__ssm_conv_s5__prompt_kernel,@function
concat_heads__ssm_conv_s5__ssm_conv_s5__prompt_kernel:
    s_cmp_ge_u32 s2, 256
    s_cbranch_scc1 L_end
    s_and_b32 s33, s2, 7
    s_lshr_b32 s4, s33, 2
    s_mul_i32 s7, s4, 72
    s_add_u32 s38, s0, s7
    s_addc_u32 s39, s1, 0
    s_load_dwordx16 s[8:23], s[38:39], 0
    s_load_dwordx2 s[24:25], s[38:39], 64
    s_load_dwordx2 s[26:27], s[0:1], 144
    s_load_dwordx4 s[28:31], s[0:1], 152
    v_lshrrev_b32 v1, 6, v0
    s_lshr_b32 s34, s2, 3
    v_readfirstlane_b32 s3, v1
    v_and_b32 v0, 63, v0
    s_and_b32 s6, s34, 7
    s_lshr_b32 s35, s34, 3
    s_and_b32 s36, s33, 3
    s_lshl_b32 s5, s35, 2
    s_add_u32 s5, s5, s36
    s_lshl_b32 s32, s4, 4
    s_add_u32 s32, s32, s5
    s_getpc_b64 s[44:45]
    s_and_b32 s44, s44, 0xffffff00
    s_mov_b32 s46, L_codeend - concat_heads__ssm_conv_s5__ssm_conv_s5__prompt_kernel
    s_mov_b32 s47, 0x20000
    s_lshl_b32 s40, s34, 3
    s_add_u32 s40, s40, s3
    s_lshl_b32 s40, s40, 7
    s_mov_b64 exec, 1
    buffer_load_dword v255, v0, s[44:47], s40 offen
    s_mov_b64 exec, -1
    s_cmp_lt_u32 s3, 4
    s_cbranch_scc1 L_compute
    s_cmp_ge_u32 s3, 6
    s_cbranch_scc1 L_aux
L_stream:
    s_sub_u32 s37, s3, 4
    v_lshrrev_b32 v1, 3, v0
    v_and_b32 v2, 7, v0
    v_lshrrev_b32 v3, 1, v1
    v_xor_b32 v2, v2, v3
    v_lshlrev_b32 v2, 4, v2
    v_xor_b32 v3, 64, v2
    s_movk_i32 s40, 1152
    v_lshrrev_b32 v30, 2, v1
    v_and_b32 v31, 1, v1
    v_lshl_add_u32 v30, v30, 1, v31
    v_bfe_u32 v31, v1, 1, 1
    v_lshl_add_u32 v30, v30, 2, v31
    v_mul_lo_u32 v30, v30, s40
    s_lshl_b32 s41, s5, 7
    s_lshl_b32 s42, s37, 6
    s_add_u32 s41, s41, s42
    s_mul_i32 s41, s41, 1152
    v_add_u32 v31, v30, v2
    s_add_u32 s42, s41, 0
    v_add_u32 v4, s42, v31
    v_add_u32 v31, v30, v3
    s_add_u32 s42, s41, 17408
    v_add_u32 v5, s42, v31
    v_add_u32 v31, v30, v2
    s_add_u32 s42, s41, 256
    v_add_u32 v6, s42, v31
    v_add_u32 v31, v30, v3
    s_add_u32 s42, s41, 17664
    v_add_u32 v7, s42, v31
    v_mul_lo_u32 v30, v1, s40
    s_lshl_b32 s45, s37, 6
    v_xor_b32 v31, s45, v2
    v_add_u32 v30, v30, v31
    s_mul_i32 s45, s6, 82944
    v_mul_lo_u32 v29, v1, s40
    v_add_u32 v31, v29, v2
    s_add_u32 s46, s45, 0
    v_add_u32 v8, s46, v31
    v_add_u32 v31, v29, v3
    s_add_u32 s46, s45, 8192
    v_add_u32 v9, s46, v31
    v_add_u32 v31, v29, v2
    s_add_u32 s46, s45, 18432
    v_add_u32 v10, s46, v31
    v_add_u32 v31, v29, v3
    s_add_u32 s46, s45, 26624
    v_add_u32 v11, s46, v31
    v_add_u32 v31, v29, v2
    s_add_u32 s46, s45, 36864
    v_add_u32 v12, s46, v31
    v_add_u32 v31, v29, v3
    s_add_u32 s46, s45, 45056
    v_add_u32 v13, s46, v31
    v_add_u32 v31, v29, v2
    s_add_u32 s46, s45, 55296
    v_add_u32 v14, s46, v31
    v_add_u32 v31, v29, v3
    s_add_u32 s46, s45, 63488
    v_add_u32 v15, s46, v31
    s_add_u32 s46, s45, 73728
    v_add_u32 v16, s46, v30
    s_lshl_b32 s47, s37, 13
    s_lshl_b32 s48, s37, 10
    s_add_u32 s50, s35, s6
    s_mul_i32 s51, s50, 11
    s_lshr_b32 s51, s51, 5
    s_mul_i32 s51, s51, 3
    s_sub_u32 s50, s50, s51
    s_mul_i32 s50, s50, 3
    s_add_u32 s50, s50, s36
    s_cmp_ge_u32 s50, 9
    s_cselect_b32 s51, 9, 0
    s_sub_u32 s50, s50, s51
    s_lshl_b32 s50, s50, 7
    s_mov_b32 s49, 0
    s_waitcnt lgkmcnt(0)
    s_mov_b32 s52, s8
    s_mov_b32 s53, s9
    s_mov_b32 s54, 2359296
    s_mov_b32 s55, 0x20000
    s_cmp_eq_u32 s37, 0
    s_cselect_b32 s56, s14, s16
    s_cselect_b32 s57, s15, s17
    s_mov_b32 s58, 663552
    s_mov_b32 s59, 0x20000
    s_setprio 2
    s_add_u32 m0, s49, s47
    s_add_u32 s51, s50, 36864
    buffer_load_dwordx4 v4, s[52:55], s50 offen offset:0  lds
    buffer_load_dwordx4 v5, s[52:55], s50 offen offset:1024  lds
    buffer_load_dwordx4 v6, s[52:55], s50 offen offset:2048  lds
    buffer_load_dwordx4 v7, s[52:55], s50 offen offset:3072  lds
    s_add_u32 m0, m0, 4096
    s_add_u32 s46, s49, s48
    buffer_load_dwordx4 v4, s[52:55], s51 offen offset:0  lds
    buffer_load_dwordx4 v5, s[52:55], s51 offen offset:1024  lds
    buffer_load_dwordx4 v6, s[52:55], s51 offen offset:2048  lds
    buffer_load_dwordx4 v7, s[52:55], s51 offen offset:3072  lds
    s_add_u32 m0, s46, 32768
    s_add_u32 s46, s46, s48
    buffer_load_dwordx4 v16, s[56:59], s50 offen  lds
    s_add_u32 m0, s46, 16384
    s_nop 0
    buffer_load_dwordx4 v8, s[56:59], s50 offen  lds
    buffer_load_dwordx4 v9, s[56:59], s50 offen offset:1024  lds
    s_add_u32 m0, s46, 20480
    s_nop 0
    buffer_load_dwordx4 v10, s[56:59], s50 offen  lds
    buffer_load_dwordx4 v11, s[56:59], s50 offen offset:1024  lds
    s_add_u32 m0, s46, 24576
    s_nop 0
    buffer_load_dwordx4 v12, s[56:59], s50 offen  lds
    buffer_load_dwordx4 v13, s[56:59], s50 offen offset:1024  lds
    s_add_u32 m0, s46, 28672
    s_nop 0
    buffer_load_dwordx4 v14, s[56:59], s50 offen  lds
    buffer_load_dwordx4 v15, s[56:59], s50 offen offset:1024  lds
    s_add_u32 s50, s50, 128
    s_cmp_ge_u32 s50, 1152
    s_cselect_b32 s50, 0, s50
    s_add_u32 s49, s49, 34816
    s_cmp_ge_u32 s49, 104448
    s_cselect_b32 s49, 0, s49
    s_setprio 1
    s_and_b32 s63, s6, 3
    s_mul_i32 s63, s63, 288
    s_mul_i32 s61, s37, 160
    s_add_u32 s61, s61, s63
    s_mul_i32 s67, s37, 10240
    s_add_u32 s67, s67, 104448
    s_mov_b32 s40, s24
    s_mov_b32 s41, s25
    s_mov_b32 s42, 1152
    s_mov_b32 s43, 0x20000
    v_and_b32 v22, 15, v0
    v_lshrrev_b32 v23, 4, v0
    v_lshlrev_b32 v38, 1, v22
    s_add_u32 m0, s49, s47
    s_add_u32 s51, s50, 36864
    buffer_load_dwordx4 v4, s[52:55], s50 offen offset:0  lds
    buffer_load_dwordx4 v5, s[52:55], s50 offen offset:1024  lds
    buffer_load_dwordx4 v6, s[52:55], s50 offen offset:2048  lds
    buffer_load_dwordx4 v7, s[52:55], s50 offen offset:3072  lds
    s_add_u32 m0, m0, 4096
    s_add_u32 s46, s49, s48
    buffer_load_dwordx4 v4, s[52:55], s51 offen offset:0  lds
    buffer_load_dwordx4 v5, s[52:55], s51 offen offset:1024  lds
    buffer_load_dwordx4 v6, s[52:55], s51 offen offset:2048  lds
    buffer_load_dwordx4 v7, s[52:55], s51 offen offset:3072  lds
    s_add_u32 m0, s46, 32768
    s_add_u32 s46, s46, s48
    buffer_load_dwordx4 v16, s[56:59], s50 offen  lds
    s_add_u32 m0, s46, 16384
    s_nop 0
    buffer_load_dwordx4 v8, s[56:59], s50 offen  lds
    buffer_load_dwordx4 v9, s[56:59], s50 offen offset:1024  lds
    s_add_u32 m0, s46, 20480
    s_nop 0
    buffer_load_dwordx4 v10, s[56:59], s50 offen  lds
    buffer_load_dwordx4 v11, s[56:59], s50 offen offset:1024  lds
    s_add_u32 m0, s46, 24576
    s_nop 0
    buffer_load_dwordx4 v12, s[56:59], s50 offen  lds
    buffer_load_dwordx4 v13, s[56:59], s50 offen offset:1024  lds
    s_add_u32 m0, s46, 28672
    s_nop 0
    buffer_load_dwordx4 v14, s[56:59], s50 offen  lds
    buffer_load_dwordx4 v15, s[56:59], s50 offen offset:1024  lds
    s_add_u32 s50, s50, 128
    s_cmp_ge_u32 s50, 1152
    s_cselect_b32 s50, 0, s50
    s_add_u32 s49, s49, 34816
    s_cmp_ge_u32 s49, 104448
    s_cselect_b32 s49, 0, s49
    v_and_b32 v24, 3, v0
    v_lshlrev_b32 v24, 2, v24
    v_add_u32 v24, 155456, v24
    v_and_b32 v25, 1, v0
    v_lshlrev_b32 v25, 2, v25
    v_add_u32 v25, 155456, v25
    s_mov_b32 s60, 2
L_s1_loop:
    s_waitcnt vmcnt(17)
    s_barrier
    s_add_u32 m0, s49, s47
    s_add_u32 s51, s50, 36864
    buffer_load_dwordx4 v4, s[52:55], s50 offen offset:0  lds
    buffer_load_dwordx4 v5, s[52:55], s50 offen offset:1024  lds
    buffer_load_dwordx4 v6, s[52:55], s50 offen offset:2048  lds
    buffer_load_dwordx4 v7, s[52:55], s50 offen offset:3072  lds
    s_add_u32 m0, m0, 4096
    s_add_u32 s46, s49, s48
    buffer_load_dwordx4 v4, s[52:55], s51 offen offset:0  lds
    buffer_load_dwordx4 v5, s[52:55], s51 offen offset:1024  lds
    buffer_load_dwordx4 v6, s[52:55], s51 offen offset:2048  lds
    buffer_load_dwordx4 v7, s[52:55], s51 offen offset:3072  lds
    s_add_u32 m0, s46, 32768
    s_add_u32 s46, s46, s48
    buffer_load_dwordx4 v16, s[56:59], s50 offen  lds
    s_add_u32 m0, s46, 16384
    s_nop 0
    buffer_load_dwordx4 v8, s[56:59], s50 offen  lds
    buffer_load_dwordx4 v9, s[56:59], s50 offen offset:1024  lds
    s_add_u32 m0, s46, 20480
    s_nop 0
    buffer_load_dwordx4 v10, s[56:59], s50 offen  lds
    buffer_load_dwordx4 v11, s[56:59], s50 offen offset:1024  lds
    s_add_u32 m0, s46, 24576
    s_nop 0
    buffer_load_dwordx4 v12, s[56:59], s50 offen  lds
    buffer_load_dwordx4 v13, s[56:59], s50 offen offset:1024  lds
    s_add_u32 m0, s46, 28672
    s_nop 0
    buffer_load_dwordx4 v14, s[56:59], s50 offen  lds
    buffer_load_dwordx4 v15, s[56:59], s50 offen offset:1024  lds
    s_add_u32 s50, s50, 128
    s_cmp_ge_u32 s50, 1152
    s_cselect_b32 s50, 0, s50
    s_add_u32 s49, s49, 34816
    s_cmp_ge_u32 s49, 104448
    s_cselect_b32 s49, 0, s49
    s_add_u32 s60, s60, 1
    s_cmp_lt_u32 s60, 9
    s_cbranch_scc1 L_s1_loop
    buffer_load_ushort v33, v38, s[40:43], s61 offen offset:0
    buffer_load_ushort v34, v38, s[40:43], s61 offen offset:32
    buffer_load_ushort v35, v38, s[40:43], s61 offen offset:64
    buffer_load_ushort v36, v38, s[40:43], s61 offen offset:96
    buffer_load_ushort v37, v38, s[40:43], s61 offen offset:128
    s_waitcnt vmcnt(22)
    s_barrier
    s_and_b32 s64, s6, 3
    s_mul_i32 s64, s64, 144
    s_lshl_b32 s65, s37, 3
    s_add_u32 s64, s64, s65
    s_mul_i32 s64, s64, 1152
    s_add_u32 s65, s64, 0
    v_add_u32 v8, s65, v30
    s_add_u32 s65, s64, 16384
    v_add_u32 v9, s65, v30
    s_add_u32 s65, s64, 36864
    v_add_u32 v10, s65, v30
    s_add_u32 s65, s64, 53248
    v_add_u32 v11, s65, v30
    s_add_u32 s65, s64, 73728
    v_add_u32 v12, s65, v30
    s_add_u32 s65, s64, 90112
    v_add_u32 v13, s65, v30
    s_add_u32 s65, s64, 110592
    v_add_u32 v14, s65, v30
    s_add_u32 s65, s64, 126976
    v_add_u32 v15, s65, v30
    s_add_u32 s65, s64, 147456
    v_add_u32 v16, s65, v30
    s_lshl_b32 s66, s35, 2
    s_lshr_b32 s65, s6, 2
    s_add_u32 s66, s66, s65
    s_add_u32 s66, s66, s36
    s_mov_b32 s10, 663552
    s_mov_b32 s11, 0x20000
    s_setprio 0
    s_waitcnt vmcnt(0)
    s_barrier
    s_add_u32 s46, s66, 5
    s_cmp_ge_u32 s46, 18
    s_cselect_b32 s45, 18, 0
    s_sub_u32 s46, s46, s45
    s_cmp_lt_u32 s46, 9
    s_cselect_b32 s8, s18, s20
    s_cselect_b32 s9, s19, s21
    s_cselect_b32 s45, 0, 9
    s_sub_u32 s46, s46, s45
    s_lshl_b32 s46, s46, 7
    s_add_u32 m0, s48, 124928
    s_nop 0
    buffer_load_dwordx4 v8, s[8:11], s46 offen lds
    buffer_load_dwordx4 v9, s[8:11], s46 offen offset:2048 lds
    s_add_u32 m0, s48, 129024
    s_nop 0
    buffer_load_dwordx4 v10, s[8:11], s46 offen lds
    buffer_load_dwordx4 v11, s[8:11], s46 offen offset:2048 lds
    s_add_u32 m0, s48, 133120
    s_nop 0
    buffer_load_dwordx4 v12, s[8:11], s46 offen lds
    buffer_load_dwordx4 v13, s[8:11], s46 offen offset:2048 lds
    s_add_u32 m0, s48, 137216
    s_nop 0
    buffer_load_dwordx4 v14, s[8:11], s46 offen lds
    buffer_load_dwordx4 v15, s[8:11], s46 offen offset:2048 lds
    s_add_u32 m0, s48, 141312
    s_nop 0
    buffer_load_dwordx4 v16, s[8:11], s46 offen lds
    v_mul_u32_u24 v29, 640, v23
    v_add_u32 v29, v29, v38
    v_add_u32 v29, s67, v29
    s_lshl_b32 s40, s37, 2
    s_add_u32 s40, s40, 155544
    v_mov_b32 v27, s40
    s_mov_b32 s72, 0
Lw_1:
    ds_read_b32 v32, v27 offset:0
    s_add_u32 s72, s72, 1
    s_cmp_ge_u32 s72, 524288
    s_waitcnt lgkmcnt(0)
    v_cmp_gt_u32 vcc, 1, v32
    s_cbranch_vccz Lwd_2
    s_cbranch_scc1 Lwd_2
    s_sleep 2
    s_branch Lw_1
Lwd_2:
    ds_read_u16 v40, v29 offset:0
    ds_read_u16 v41, v29 offset:160
    ds_read_u16 v42, v29 offset:320
    ds_read_u16 v43, v29 offset:480
    ds_read_u16 v44, v29 offset:2560
    ds_read_u16 v45, v29 offset:2720
    ds_read_u16 v46, v29 offset:2880
    ds_read_u16 v47, v29 offset:3040
    ds_read_u16 v48, v29 offset:32
    ds_read_u16 v49, v29 offset:192
    ds_read_u16 v50, v29 offset:352
    ds_read_u16 v51, v29 offset:512
    ds_read_u16 v52, v29 offset:2592
    ds_read_u16 v53, v29 offset:2752
    ds_read_u16 v54, v29 offset:2912
    ds_read_u16 v55, v29 offset:3072
    ds_read_u16 v56, v29 offset:64
    ds_read_u16 v57, v29 offset:224
    ds_read_u16 v58, v29 offset:384
    ds_read_u16 v59, v29 offset:544
    ds_read_u16 v60, v29 offset:2624
    ds_read_u16 v61, v29 offset:2784
    ds_read_u16 v62, v29 offset:2944
    ds_read_u16 v63, v29 offset:3104
    ds_read_u16 v64, v29 offset:96
    ds_read_u16 v65, v29 offset:256
    ds_read_u16 v66, v29 offset:416
    ds_read_u16 v67, v29 offset:576
    ds_read_u16 v68, v29 offset:2656
    ds_read_u16 v69, v29 offset:2816
    ds_read_u16 v70, v29 offset:2976
    ds_read_u16 v71, v29 offset:3136
    ds_read_u16 v72, v29 offset:128
    ds_read_u16 v73, v29 offset:288
    ds_read_u16 v74, v29 offset:448
    ds_read_u16 v75, v29 offset:608
    ds_read_u16 v76, v29 offset:2688
    ds_read_u16 v77, v29 offset:2848
    ds_read_u16 v78, v29 offset:3008
    ds_read_u16 v79, v29 offset:3168
    ds_read_u16 v80, v29 offset:5120
    ds_read_u16 v81, v29 offset:5280
    ds_read_u16 v82, v29 offset:5440
    ds_read_u16 v83, v29 offset:5600
    ds_read_u16 v84, v29 offset:7680
    ds_read_u16 v85, v29 offset:7840
    ds_read_u16 v86, v29 offset:8000
    ds_read_u16 v87, v29 offset:8160
    ds_read_u16 v88, v29 offset:5152
    ds_read_u16 v89, v29 offset:5312
    ds_read_u16 v90, v29 offset:5472
    ds_read_u16 v91, v29 offset:5632
    ds_read_u16 v92, v29 offset:7712
    ds_read_u16 v93, v29 offset:7872
    ds_read_u16 v94, v29 offset:8032
    ds_read_u16 v95, v29 offset:8192
    ds_read_u16 v96, v29 offset:5184
    ds_read_u16 v97, v29 offset:5344
    ds_read_u16 v98, v29 offset:5504
    ds_read_u16 v99, v29 offset:5664
    ds_read_u16 v100, v29 offset:7744
    ds_read_u16 v101, v29 offset:7904
    ds_read_u16 v102, v29 offset:8064
    ds_read_u16 v103, v29 offset:8224
    ds_read_u16 v104, v29 offset:5216
    ds_read_u16 v105, v29 offset:5376
    ds_read_u16 v106, v29 offset:5536
    ds_read_u16 v107, v29 offset:5696
    ds_read_u16 v108, v29 offset:7776
    ds_read_u16 v109, v29 offset:7936
    ds_read_u16 v110, v29 offset:8096
    ds_read_u16 v111, v29 offset:8256
    ds_read_u16 v112, v29 offset:5248
    ds_read_u16 v113, v29 offset:5408
    ds_read_u16 v114, v29 offset:5568
    ds_read_u16 v115, v29 offset:5728
    ds_read_u16 v116, v29 offset:7808
    ds_read_u16 v117, v29 offset:7968
    ds_read_u16 v118, v29 offset:8128
    ds_read_u16 v119, v29 offset:8288
    s_lshl_b32 s40, s37, 2
    s_add_u32 s40, s40, 155456
    v_mov_b32 v27, s40
    v_mov_b32 v28, 1
    s_waitcnt lgkmcnt(0)
    s_mov_b64 exec, 1
    ds_write_b32 v27, v28 offset:0
    s_mov_b64 exec, -1
    v_lshlrev_b32 v33, 16, v33
    v_lshlrev_b32 v34, 16, v34
    v_lshlrev_b32 v35, 16, v35
    v_lshlrev_b32 v36, 16, v36
    v_lshlrev_b32 v37, 16, v37
    v_lshlrev_b32 v40, 16, v40
    v_lshlrev_b32 v41, 16, v41
    v_lshlrev_b32 v42, 16, v42
    v_lshlrev_b32 v43, 16, v43
    v_lshlrev_b32 v44, 16, v44
    v_lshlrev_b32 v45, 16, v45
    v_lshlrev_b32 v46, 16, v46
    v_lshlrev_b32 v47, 16, v47
    v_mul_f32 v40, v40, v33
    v_mul_f32 v41, v41, v33
    v_mul_f32 v42, v42, v33
    v_mul_f32 v43, v43, v33
    v_mul_f32 v44, v44, v33
    v_mul_f32 v45, v45, v33
    v_mul_f32 v46, v46, v33
    v_mul_f32 v47, v47, v33
    v_cvt_pk_bf16_f32 v120, v40, v41
    v_cvt_pk_bf16_f32 v121, v42, v43
    v_cvt_pk_bf16_f32 v122, v44, v45
    v_cvt_pk_bf16_f32 v123, v46, v47
    v_lshlrev_b32 v48, 16, v48
    v_lshlrev_b32 v49, 16, v49
    v_lshlrev_b32 v50, 16, v50
    v_lshlrev_b32 v51, 16, v51
    v_lshlrev_b32 v52, 16, v52
    v_lshlrev_b32 v53, 16, v53
    v_lshlrev_b32 v54, 16, v54
    v_lshlrev_b32 v55, 16, v55
    v_mul_f32 v48, v48, v34
    v_mul_f32 v49, v49, v34
    v_mul_f32 v50, v50, v34
    v_mul_f32 v51, v51, v34
    v_mul_f32 v52, v52, v34
    v_mul_f32 v53, v53, v34
    v_mul_f32 v54, v54, v34
    v_mul_f32 v55, v55, v34
    v_cvt_pk_bf16_f32 v124, v48, v49
    v_cvt_pk_bf16_f32 v125, v50, v51
    v_cvt_pk_bf16_f32 v126, v52, v53
    v_cvt_pk_bf16_f32 v127, v54, v55
    v_lshlrev_b32 v56, 16, v56
    v_lshlrev_b32 v57, 16, v57
    v_lshlrev_b32 v58, 16, v58
    v_lshlrev_b32 v59, 16, v59
    v_lshlrev_b32 v60, 16, v60
    v_lshlrev_b32 v61, 16, v61
    v_lshlrev_b32 v62, 16, v62
    v_lshlrev_b32 v63, 16, v63
    v_mul_f32 v56, v56, v35
    v_mul_f32 v57, v57, v35
    v_mul_f32 v58, v58, v35
    v_mul_f32 v59, v59, v35
    v_mul_f32 v60, v60, v35
    v_mul_f32 v61, v61, v35
    v_mul_f32 v62, v62, v35
    v_mul_f32 v63, v63, v35
    v_cvt_pk_bf16_f32 v128, v56, v57
    v_cvt_pk_bf16_f32 v129, v58, v59
    v_cvt_pk_bf16_f32 v130, v60, v61
    v_cvt_pk_bf16_f32 v131, v62, v63
    v_lshlrev_b32 v64, 16, v64
    v_lshlrev_b32 v65, 16, v65
    v_lshlrev_b32 v66, 16, v66
    v_lshlrev_b32 v67, 16, v67
    v_lshlrev_b32 v68, 16, v68
    v_lshlrev_b32 v69, 16, v69
    v_lshlrev_b32 v70, 16, v70
    v_lshlrev_b32 v71, 16, v71
    v_mul_f32 v64, v64, v36
    v_mul_f32 v65, v65, v36
    v_mul_f32 v66, v66, v36
    v_mul_f32 v67, v67, v36
    v_mul_f32 v68, v68, v36
    v_mul_f32 v69, v69, v36
    v_mul_f32 v70, v70, v36
    v_mul_f32 v71, v71, v36
    v_cvt_pk_bf16_f32 v132, v64, v65
    v_cvt_pk_bf16_f32 v133, v66, v67
    v_cvt_pk_bf16_f32 v134, v68, v69
    v_cvt_pk_bf16_f32 v135, v70, v71
    v_lshlrev_b32 v72, 16, v72
    v_lshlrev_b32 v73, 16, v73
    v_lshlrev_b32 v74, 16, v74
    v_lshlrev_b32 v75, 16, v75
    v_lshlrev_b32 v76, 16, v76
    v_lshlrev_b32 v77, 16, v77
    v_lshlrev_b32 v78, 16, v78
    v_lshlrev_b32 v79, 16, v79
    v_mul_f32 v72, v72, v37
    v_mul_f32 v73, v73, v37
    v_mul_f32 v74, v74, v37
    v_mul_f32 v75, v75, v37
    v_mul_f32 v76, v76, v37
    v_mul_f32 v77, v77, v37
    v_mul_f32 v78, v78, v37
    v_mul_f32 v79, v79, v37
    v_cvt_pk_bf16_f32 v136, v72, v73
    v_cvt_pk_bf16_f32 v137, v74, v75
    v_cvt_pk_bf16_f32 v138, v76, v77
    v_cvt_pk_bf16_f32 v139, v78, v79
    v_lshlrev_b32 v80, 16, v80
    v_lshlrev_b32 v81, 16, v81
    v_lshlrev_b32 v82, 16, v82
    v_lshlrev_b32 v83, 16, v83
    v_lshlrev_b32 v84, 16, v84
    v_lshlrev_b32 v85, 16, v85
    v_lshlrev_b32 v86, 16, v86
    v_lshlrev_b32 v87, 16, v87
    v_mul_f32 v80, v80, v33
    v_mul_f32 v81, v81, v33
    v_mul_f32 v82, v82, v33
    v_mul_f32 v83, v83, v33
    v_mul_f32 v84, v84, v33
    v_mul_f32 v85, v85, v33
    v_mul_f32 v86, v86, v33
    v_mul_f32 v87, v87, v33
    v_cvt_pk_bf16_f32 v140, v80, v81
    v_cvt_pk_bf16_f32 v141, v82, v83
    v_cvt_pk_bf16_f32 v142, v84, v85
    v_cvt_pk_bf16_f32 v143, v86, v87
    v_lshlrev_b32 v88, 16, v88
    v_lshlrev_b32 v89, 16, v89
    v_lshlrev_b32 v90, 16, v90
    v_lshlrev_b32 v91, 16, v91
    v_lshlrev_b32 v92, 16, v92
    v_lshlrev_b32 v93, 16, v93
    v_lshlrev_b32 v94, 16, v94
    v_lshlrev_b32 v95, 16, v95
    v_mul_f32 v88, v88, v34
    v_mul_f32 v89, v89, v34
    v_mul_f32 v90, v90, v34
    v_mul_f32 v91, v91, v34
    v_mul_f32 v92, v92, v34
    v_mul_f32 v93, v93, v34
    v_mul_f32 v94, v94, v34
    v_mul_f32 v95, v95, v34
    v_cvt_pk_bf16_f32 v144, v88, v89
    v_cvt_pk_bf16_f32 v145, v90, v91
    v_cvt_pk_bf16_f32 v146, v92, v93
    v_cvt_pk_bf16_f32 v147, v94, v95
    v_lshlrev_b32 v96, 16, v96
    v_lshlrev_b32 v97, 16, v97
    v_lshlrev_b32 v98, 16, v98
    v_lshlrev_b32 v99, 16, v99
    v_lshlrev_b32 v100, 16, v100
    v_lshlrev_b32 v101, 16, v101
    v_lshlrev_b32 v102, 16, v102
    v_lshlrev_b32 v103, 16, v103
    v_mul_f32 v96, v96, v35
    v_mul_f32 v97, v97, v35
    v_mul_f32 v98, v98, v35
    v_mul_f32 v99, v99, v35
    v_mul_f32 v100, v100, v35
    v_mul_f32 v101, v101, v35
    v_mul_f32 v102, v102, v35
    v_mul_f32 v103, v103, v35
    v_cvt_pk_bf16_f32 v148, v96, v97
    v_cvt_pk_bf16_f32 v149, v98, v99
    v_cvt_pk_bf16_f32 v150, v100, v101
    v_cvt_pk_bf16_f32 v151, v102, v103
    v_lshlrev_b32 v104, 16, v104
    v_lshlrev_b32 v105, 16, v105
    v_lshlrev_b32 v106, 16, v106
    v_lshlrev_b32 v107, 16, v107
    v_lshlrev_b32 v108, 16, v108
    v_lshlrev_b32 v109, 16, v109
    v_lshlrev_b32 v110, 16, v110
    v_lshlrev_b32 v111, 16, v111
    v_mul_f32 v104, v104, v36
    v_mul_f32 v105, v105, v36
    v_mul_f32 v106, v106, v36
    v_mul_f32 v107, v107, v36
    v_mul_f32 v108, v108, v36
    v_mul_f32 v109, v109, v36
    v_mul_f32 v110, v110, v36
    v_mul_f32 v111, v111, v36
    v_cvt_pk_bf16_f32 v152, v104, v105
    v_cvt_pk_bf16_f32 v153, v106, v107
    v_cvt_pk_bf16_f32 v154, v108, v109
    v_cvt_pk_bf16_f32 v155, v110, v111
    v_lshlrev_b32 v112, 16, v112
    v_lshlrev_b32 v113, 16, v113
    v_lshlrev_b32 v114, 16, v114
    v_lshlrev_b32 v115, 16, v115
    v_lshlrev_b32 v116, 16, v116
    v_lshlrev_b32 v117, 16, v117
    v_lshlrev_b32 v118, 16, v118
    v_lshlrev_b32 v119, 16, v119
    v_mul_f32 v112, v112, v37
    v_mul_f32 v113, v113, v37
    v_mul_f32 v114, v114, v37
    v_mul_f32 v115, v115, v37
    v_mul_f32 v116, v116, v37
    v_mul_f32 v117, v117, v37
    v_mul_f32 v118, v118, v37
    v_mul_f32 v119, v119, v37
    v_cvt_pk_bf16_f32 v156, v112, v113
    v_cvt_pk_bf16_f32 v157, v114, v115
    v_cvt_pk_bf16_f32 v158, v116, v117
    v_cvt_pk_bf16_f32 v159, v118, v119
    v_lshlrev_b32 v31, 4, v0
    s_mul_i32 s40, s37, 10240
    v_add_u32 v31, s40, v31
    s_mov_b32 s72, 0
Lw_3:
    ds_read_b32 v32, v24 offset:48
    s_add_u32 s72, s72, 1
    s_cmp_ge_u32 s72, 524288
    s_waitcnt lgkmcnt(0)
    v_cmp_gt_u32 vcc, 1, v32
    s_cbranch_vccz Lwd_4
    s_cbranch_scc1 Lwd_4
    s_sleep 2
    s_branch Lw_3
Lwd_4:
    ds_write_b128 v31, v[120:123] offset:0
    ds_write_b128 v31, v[124:127] offset:1024
    ds_write_b128 v31, v[128:131] offset:2048
    ds_write_b128 v31, v[132:135] offset:3072
    ds_write_b128 v31, v[136:139] offset:4096
    ds_write_b128 v31, v[140:143] offset:5120
    ds_write_b128 v31, v[144:147] offset:6144
    ds_write_b128 v31, v[148:151] offset:7168
    ds_write_b128 v31, v[152:155] offset:8192
    ds_write_b128 v31, v[156:159] offset:9216
    s_mov_b64 exec, 1
    ds_write_b32 v27, v28 offset:32
    s_mov_b64 exec, -1
    s_mov_b32 s72, 0
Lw_5:
    ds_read_b32 v32, v25 offset:0
    s_add_u32 s72, s72, 1
    s_cmp_ge_u32 s72, 524288
    s_waitcnt lgkmcnt(0)
    v_cmp_gt_u32 vcc, 1, v32
    s_cbranch_vccz Lwd_6
    s_cbranch_scc1 Lwd_6
    s_sleep 2
    s_branch Lw_5
Lwd_6:
    s_mov_b32 s72, 0
Lw_7:
    ds_read_b32 v32, v25 offset:80
    s_add_u32 s72, s72, 1
    s_cmp_ge_u32 s72, 524288
    s_waitcnt lgkmcnt(0)
    v_cmp_gt_u32 vcc, 1, v32
    s_cbranch_vccz Lwd_8
    s_cbranch_scc1 Lwd_8
    s_sleep 1
    s_branch Lw_7
Lwd_8:
    s_add_u32 s46, s66, 0
    s_cmp_ge_u32 s46, 18
    s_cselect_b32 s45, 18, 0
    s_sub_u32 s46, s46, s45
    s_cmp_lt_u32 s46, 9
    s_cselect_b32 s8, s18, s20
    s_cselect_b32 s9, s19, s21
    s_cselect_b32 s45, 0, 9
    s_sub_u32 s46, s46, s45
    s_lshl_b32 s46, s46, 7
    s_add_u32 m0, s48, 32768
    s_nop 0
    buffer_load_dwordx4 v8, s[8:11], s46 offen lds
    buffer_load_dwordx4 v9, s[8:11], s46 offen offset:2048 lds
    s_add_u32 m0, s48, 36864
    s_nop 0
    buffer_load_dwordx4 v10, s[8:11], s46 offen lds
    buffer_load_dwordx4 v11, s[8:11], s46 offen offset:2048 lds
    s_add_u32 m0, s48, 40960
    s_nop 0
    buffer_load_dwordx4 v12, s[8:11], s46 offen lds
    buffer_load_dwordx4 v13, s[8:11], s46 offen offset:2048 lds
    s_add_u32 m0, s48, 45056
    s_nop 0
    buffer_load_dwordx4 v14, s[8:11], s46 offen lds
    buffer_load_dwordx4 v15, s[8:11], s46 offen offset:2048 lds
    s_add_u32 m0, s48, 49152
    s_nop 0
    buffer_load_dwordx4 v16, s[8:11], s46 offen lds
    s_add_u32 s46, s66, 1
    s_cmp_ge_u32 s46, 18
    s_cselect_b32 s45, 18, 0
    s_sub_u32 s46, s46, s45
    s_cmp_lt_u32 s46, 9
    s_cselect_b32 s8, s18, s20
    s_cselect_b32 s9, s19, s21
    s_cselect_b32 s45, 0, 9
    s_sub_u32 s46, s46, s45
    s_lshl_b32 s46, s46, 7
    s_add_u32 m0, s48, 51200
    s_nop 0
    buffer_load_dwordx4 v8, s[8:11], s46 offen lds
    buffer_load_dwordx4 v9, s[8:11], s46 offen offset:2048 lds
    s_add_u32 m0, s48, 55296
    s_nop 0
    buffer_load_dwordx4 v10, s[8:11], s46 offen lds
    buffer_load_dwordx4 v11, s[8:11], s46 offen offset:2048 lds
    s_add_u32 m0, s48, 59392
    s_nop 0
    buffer_load_dwordx4 v12, s[8:11], s46 offen lds
    buffer_load_dwordx4 v13, s[8:11], s46 offen offset:2048 lds
    s_add_u32 m0, s48, 63488
    s_nop 0
    buffer_load_dwordx4 v14, s[8:11], s46 offen lds
    buffer_load_dwordx4 v15, s[8:11], s46 offen offset:2048 lds
    s_add_u32 m0, s48, 67584
    s_nop 0
    buffer_load_dwordx4 v16, s[8:11], s46 offen lds
    s_add_u32 s46, s66, 2
    s_cmp_ge_u32 s46, 18
    s_cselect_b32 s45, 18, 0
    s_sub_u32 s46, s46, s45
    s_cmp_lt_u32 s46, 9
    s_cselect_b32 s8, s18, s20
    s_cselect_b32 s9, s19, s21
    s_cselect_b32 s45, 0, 9
    s_sub_u32 s46, s46, s45
    s_lshl_b32 s46, s46, 7
    s_add_u32 m0, s48, 69632
    s_nop 0
    buffer_load_dwordx4 v8, s[8:11], s46 offen lds
    buffer_load_dwordx4 v9, s[8:11], s46 offen offset:2048 lds
    s_add_u32 m0, s48, 73728
    s_nop 0
    buffer_load_dwordx4 v10, s[8:11], s46 offen lds
    buffer_load_dwordx4 v11, s[8:11], s46 offen offset:2048 lds
    s_add_u32 m0, s48, 77824
    s_nop 0
    buffer_load_dwordx4 v12, s[8:11], s46 offen lds
    buffer_load_dwordx4 v13, s[8:11], s46 offen offset:2048 lds
    s_add_u32 m0, s48, 81920
    s_nop 0
    buffer_load_dwordx4 v14, s[8:11], s46 offen lds
    buffer_load_dwordx4 v15, s[8:11], s46 offen offset:2048 lds
    s_add_u32 m0, s48, 86016
    s_nop 0
    buffer_load_dwordx4 v16, s[8:11], s46 offen lds
    s_add_u32 s46, s66, 3
    s_cmp_ge_u32 s46, 18
    s_cselect_b32 s45, 18, 0
    s_sub_u32 s46, s46, s45
    s_cmp_lt_u32 s46, 9
    s_cselect_b32 s8, s18, s20
    s_cselect_b32 s9, s19, s21
    s_cselect_b32 s45, 0, 9
    s_sub_u32 s46, s46, s45
    s_lshl_b32 s46, s46, 7
    s_add_u32 m0, s48, 88064
    s_nop 0
    buffer_load_dwordx4 v8, s[8:11], s46 offen lds
    buffer_load_dwordx4 v9, s[8:11], s46 offen offset:2048 lds
    s_add_u32 m0, s48, 92160
    s_nop 0
    buffer_load_dwordx4 v10, s[8:11], s46 offen lds
    buffer_load_dwordx4 v11, s[8:11], s46 offen offset:2048 lds
    s_add_u32 m0, s48, 96256
    s_nop 0
    buffer_load_dwordx4 v12, s[8:11], s46 offen lds
    buffer_load_dwordx4 v13, s[8:11], s46 offen offset:2048 lds
    s_add_u32 m0, s48, 100352
    s_nop 0
    buffer_load_dwordx4 v14, s[8:11], s46 offen lds
    buffer_load_dwordx4 v15, s[8:11], s46 offen offset:2048 lds
    s_add_u32 m0, s48, 104448
    s_nop 0
    buffer_load_dwordx4 v16, s[8:11], s46 offen lds
    s_add_u32 s46, s66, 4
    s_cmp_ge_u32 s46, 18
    s_cselect_b32 s45, 18, 0
    s_sub_u32 s46, s46, s45
    s_cmp_lt_u32 s46, 9
    s_cselect_b32 s8, s18, s20
    s_cselect_b32 s9, s19, s21
    s_cselect_b32 s45, 0, 9
    s_sub_u32 s46, s46, s45
    s_lshl_b32 s46, s46, 7
    s_add_u32 m0, s48, 106496
    s_nop 0
    buffer_load_dwordx4 v8, s[8:11], s46 offen lds
    buffer_load_dwordx4 v9, s[8:11], s46 offen offset:2048 lds
    s_add_u32 m0, s48, 110592
    s_nop 0
    buffer_load_dwordx4 v10, s[8:11], s46 offen lds
    buffer_load_dwordx4 v11, s[8:11], s46 offen offset:2048 lds
    s_add_u32 m0, s48, 114688
    s_nop 0
    buffer_load_dwordx4 v12, s[8:11], s46 offen lds
    buffer_load_dwordx4 v13, s[8:11], s46 offen offset:2048 lds
    s_add_u32 m0, s48, 118784
    s_nop 0
    buffer_load_dwordx4 v14, s[8:11], s46 offen lds
    buffer_load_dwordx4 v15, s[8:11], s46 offen offset:2048 lds
    s_add_u32 m0, s48, 122880
    s_nop 0
    buffer_load_dwordx4 v16, s[8:11], s46 offen lds
    s_setprio 0
    s_waitcnt vmcnt(36)
    s_barrier
    s_waitcnt vmcnt(27)
    s_barrier
    s_add_u32 s46, s66, 6
    s_cmp_ge_u32 s46, 18
    s_cselect_b32 s45, 18, 0
    s_sub_u32 s46, s46, s45
    s_cmp_lt_u32 s46, 9
    s_cselect_b32 s8, s18, s20
    s_cselect_b32 s9, s19, s21
    s_cselect_b32 s45, 0, 9
    s_sub_u32 s46, s46, s45
    s_lshl_b32 s46, s46, 7
    s_add_u32 m0, s48, 32768
    s_nop 0
    buffer_load_dwordx4 v8, s[8:11], s46 offen offset:0 lds
    s_add_u32 m0, s48, 32768
    s_nop 0
    buffer_load_dwordx4 v9, s[8:11], s46 offen offset:2048 lds
    s_add_u32 m0, s48, 36864
    s_nop 0
    buffer_load_dwordx4 v10, s[8:11], s46 offen offset:0 lds
    s_add_u32 m0, s48, 36864
    s_nop 0
    buffer_load_dwordx4 v11, s[8:11], s46 offen offset:2048 lds
    s_add_u32 m0, s48, 40960
    s_nop 0
    buffer_load_dwordx4 v12, s[8:11], s46 offen offset:0 lds
    s_add_u32 m0, s48, 40960
    s_nop 0
    buffer_load_dwordx4 v13, s[8:11], s46 offen offset:2048 lds
    s_add_u32 m0, s48, 45056
    s_nop 0
    buffer_load_dwordx4 v14, s[8:11], s46 offen offset:0 lds
    s_add_u32 m0, s48, 45056
    s_nop 0
    buffer_load_dwordx4 v15, s[8:11], s46 offen offset:2048 lds
    s_waitcnt vmcnt(26)
    s_barrier
    s_add_u32 m0, s48, 49152
    s_nop 0
    buffer_load_dwordx4 v16, s[8:11], s46 offen offset:0 lds
    s_add_u32 s46, s66, 7
    s_cmp_ge_u32 s46, 18
    s_cselect_b32 s45, 18, 0
    s_sub_u32 s46, s46, s45
    s_cmp_lt_u32 s46, 9
    s_cselect_b32 s8, s18, s20
    s_cselect_b32 s9, s19, s21
    s_cselect_b32 s45, 0, 9
    s_sub_u32 s46, s46, s45
    s_lshl_b32 s46, s46, 7
    s_add_u32 m0, s48, 51200
    s_nop 0
    buffer_load_dwordx4 v8, s[8:11], s46 offen offset:0 lds
    s_add_u32 m0, s48, 51200
    s_nop 0
    buffer_load_dwordx4 v9, s[8:11], s46 offen offset:2048 lds
    s_add_u32 m0, s48, 55296
    s_nop 0
    buffer_load_dwordx4 v10, s[8:11], s46 offen offset:0 lds
    s_add_u32 m0, s48, 55296
    s_nop 0
    buffer_load_dwordx4 v11, s[8:11], s46 offen offset:2048 lds
    s_add_u32 m0, s48, 59392
    s_nop 0
    buffer_load_dwordx4 v12, s[8:11], s46 offen offset:0 lds
    s_add_u32 m0, s48, 59392
    s_nop 0
    buffer_load_dwordx4 v13, s[8:11], s46 offen offset:2048 lds
    s_waitcnt vmcnt(24)
    s_barrier
    s_add_u32 m0, s48, 63488
    s_nop 0
    buffer_load_dwordx4 v14, s[8:11], s46 offen offset:0 lds
    s_add_u32 m0, s48, 63488
    s_nop 0
    buffer_load_dwordx4 v15, s[8:11], s46 offen offset:2048 lds
    s_add_u32 m0, s48, 67584
    s_nop 0
    buffer_load_dwordx4 v16, s[8:11], s46 offen offset:0 lds
    s_add_u32 s46, s66, 8
    s_cmp_ge_u32 s46, 18
    s_cselect_b32 s45, 18, 0
    s_sub_u32 s46, s46, s45
    s_cmp_lt_u32 s46, 9
    s_cselect_b32 s8, s18, s20
    s_cselect_b32 s9, s19, s21
    s_cselect_b32 s45, 0, 9
    s_sub_u32 s46, s46, s45
    s_lshl_b32 s46, s46, 7
    s_add_u32 m0, s48, 69632
    s_nop 0
    buffer_load_dwordx4 v8, s[8:11], s46 offen offset:0 lds
    s_add_u32 m0, s48, 69632
    s_nop 0
    buffer_load_dwordx4 v9, s[8:11], s46 offen offset:2048 lds
    s_add_u32 m0, s48, 73728
    s_nop 0
    buffer_load_dwordx4 v10, s[8:11], s46 offen offset:0 lds
    s_add_u32 m0, s48, 73728
    s_nop 0
    buffer_load_dwordx4 v11, s[8:11], s46 offen offset:2048 lds
    s_add_u32 m0, s48, 77824
    s_nop 0
    buffer_load_dwordx4 v12, s[8:11], s46 offen offset:0 lds
    s_waitcnt vmcnt(23)
    s_barrier
    s_add_u32 m0, s48, 77824
    s_nop 0
    buffer_load_dwordx4 v13, s[8:11], s46 offen offset:2048 lds
    s_add_u32 m0, s48, 81920
    s_nop 0
    buffer_load_dwordx4 v14, s[8:11], s46 offen offset:0 lds
    s_add_u32 m0, s48, 81920
    s_nop 0
    buffer_load_dwordx4 v15, s[8:11], s46 offen offset:2048 lds
    s_add_u32 m0, s48, 86016
    s_nop 0
    buffer_load_dwordx4 v16, s[8:11], s46 offen offset:0 lds
    s_add_u32 s46, s66, 9
    s_cmp_ge_u32 s46, 18
    s_cselect_b32 s45, 18, 0
    s_sub_u32 s46, s46, s45
    s_cmp_lt_u32 s46, 9
    s_cselect_b32 s8, s18, s20
    s_cselect_b32 s9, s19, s21
    s_cselect_b32 s45, 0, 9
    s_sub_u32 s46, s46, s45
    s_lshl_b32 s46, s46, 7
    s_add_u32 m0, s48, 88064
    s_nop 0
    buffer_load_dwordx4 v8, s[8:11], s46 offen offset:0 lds
    s_add_u32 m0, s48, 88064
    s_nop 0
    buffer_load_dwordx4 v9, s[8:11], s46 offen offset:2048 lds
    s_add_u32 m0, s48, 92160
    s_nop 0
    buffer_load_dwordx4 v10, s[8:11], s46 offen offset:0 lds
    s_barrier
    s_add_u32 m0, s48, 92160
    s_nop 0
    buffer_load_dwordx4 v11, s[8:11], s46 offen offset:2048 lds
    s_add_u32 m0, s48, 96256
    s_nop 0
    buffer_load_dwordx4 v12, s[8:11], s46 offen offset:0 lds
    s_add_u32 m0, s48, 96256
    s_nop 0
    buffer_load_dwordx4 v13, s[8:11], s46 offen offset:2048 lds
    s_add_u32 m0, s48, 100352
    s_nop 0
    buffer_load_dwordx4 v14, s[8:11], s46 offen offset:0 lds
    s_add_u32 m0, s48, 100352
    s_nop 0
    buffer_load_dwordx4 v15, s[8:11], s46 offen offset:2048 lds
    s_add_u32 m0, s48, 104448
    s_nop 0
    buffer_load_dwordx4 v16, s[8:11], s46 offen offset:0 lds
    s_add_u32 s46, s66, 10
    s_cmp_ge_u32 s46, 18
    s_cselect_b32 s45, 18, 0
    s_sub_u32 s46, s46, s45
    s_cmp_lt_u32 s46, 9
    s_cselect_b32 s8, s18, s20
    s_cselect_b32 s9, s19, s21
    s_cselect_b32 s45, 0, 9
    s_sub_u32 s46, s46, s45
    s_lshl_b32 s46, s46, 7
    s_add_u32 m0, s48, 106496
    s_nop 0
    buffer_load_dwordx4 v8, s[8:11], s46 offen offset:0 lds
    s_add_u32 m0, s48, 106496
    s_nop 0
    buffer_load_dwordx4 v9, s[8:11], s46 offen offset:2048 lds
    s_waitcnt vmcnt(29)
    s_barrier
    s_add_u32 m0, s48, 110592
    s_nop 0
    buffer_load_dwordx4 v10, s[8:11], s46 offen offset:0 lds
    s_add_u32 m0, s48, 110592
    s_nop 0
    buffer_load_dwordx4 v11, s[8:11], s46 offen offset:2048 lds
    s_add_u32 m0, s48, 114688
    s_nop 0
    buffer_load_dwordx4 v12, s[8:11], s46 offen offset:0 lds
    s_add_u32 m0, s48, 114688
    s_nop 0
    buffer_load_dwordx4 v13, s[8:11], s46 offen offset:2048 lds
    s_add_u32 m0, s48, 118784
    s_nop 0
    buffer_load_dwordx4 v14, s[8:11], s46 offen offset:0 lds
    s_add_u32 m0, s48, 118784
    s_nop 0
    buffer_load_dwordx4 v15, s[8:11], s46 offen offset:2048 lds
    s_add_u32 m0, s48, 122880
    s_nop 0
    buffer_load_dwordx4 v16, s[8:11], s46 offen offset:0 lds
    s_waitcnt vmcnt(27)
    s_barrier
    s_add_u32 s46, s66, 11
    s_cmp_ge_u32 s46, 18
    s_cselect_b32 s45, 18, 0
    s_sub_u32 s46, s46, s45
    s_cmp_lt_u32 s46, 9
    s_cselect_b32 s8, s18, s20
    s_cselect_b32 s9, s19, s21
    s_cselect_b32 s45, 0, 9
    s_sub_u32 s46, s46, s45
    s_lshl_b32 s46, s46, 7
    s_add_u32 m0, s48, 124928
    s_nop 0
    buffer_load_dwordx4 v8, s[8:11], s46 offen offset:0 lds
    s_add_u32 m0, s48, 124928
    s_nop 0
    buffer_load_dwordx4 v9, s[8:11], s46 offen offset:2048 lds
    s_add_u32 m0, s48, 129024
    s_nop 0
    buffer_load_dwordx4 v10, s[8:11], s46 offen offset:0 lds
    s_add_u32 m0, s48, 129024
    s_nop 0
    buffer_load_dwordx4 v11, s[8:11], s46 offen offset:2048 lds
    s_add_u32 m0, s48, 133120
    s_nop 0
    buffer_load_dwordx4 v12, s[8:11], s46 offen offset:0 lds
    s_add_u32 m0, s48, 133120
    s_nop 0
    buffer_load_dwordx4 v13, s[8:11], s46 offen offset:2048 lds
    s_add_u32 m0, s48, 137216
    s_nop 0
    buffer_load_dwordx4 v14, s[8:11], s46 offen offset:0 lds
    s_add_u32 m0, s48, 137216
    s_nop 0
    buffer_load_dwordx4 v15, s[8:11], s46 offen offset:2048 lds
    s_waitcnt vmcnt(26)
    s_barrier
    s_add_u32 m0, s48, 141312
    s_nop 0
    buffer_load_dwordx4 v16, s[8:11], s46 offen offset:0 lds
    s_add_u32 s46, s66, 12
    s_cmp_ge_u32 s46, 18
    s_cselect_b32 s45, 18, 0
    s_sub_u32 s46, s46, s45
    s_cmp_lt_u32 s46, 9
    s_cselect_b32 s8, s18, s20
    s_cselect_b32 s9, s19, s21
    s_cselect_b32 s45, 0, 9
    s_sub_u32 s46, s46, s45
    s_lshl_b32 s46, s46, 7
    s_add_u32 m0, s48, 32768
    s_nop 0
    buffer_load_dwordx4 v8, s[8:11], s46 offen offset:0 lds
    s_add_u32 m0, s48, 32768
    s_nop 0
    buffer_load_dwordx4 v9, s[8:11], s46 offen offset:2048 lds
    s_add_u32 m0, s48, 36864
    s_nop 0
    buffer_load_dwordx4 v10, s[8:11], s46 offen offset:0 lds
    s_add_u32 m0, s48, 36864
    s_nop 0
    buffer_load_dwordx4 v11, s[8:11], s46 offen offset:2048 lds
    s_add_u32 m0, s48, 40960
    s_nop 0
    buffer_load_dwordx4 v12, s[8:11], s46 offen offset:0 lds
    s_add_u32 m0, s48, 40960
    s_nop 0
    buffer_load_dwordx4 v13, s[8:11], s46 offen offset:2048 lds
    s_waitcnt vmcnt(24)
    s_barrier
    s_add_u32 m0, s48, 45056
    s_nop 0
    buffer_load_dwordx4 v14, s[8:11], s46 offen offset:0 lds
    s_add_u32 m0, s48, 45056
    s_nop 0
    buffer_load_dwordx4 v15, s[8:11], s46 offen offset:2048 lds
    s_add_u32 m0, s48, 49152
    s_nop 0
    buffer_load_dwordx4 v16, s[8:11], s46 offen offset:0 lds
    s_add_u32 s46, s66, 13
    s_cmp_ge_u32 s46, 18
    s_cselect_b32 s45, 18, 0
    s_sub_u32 s46, s46, s45
    s_cmp_lt_u32 s46, 9
    s_cselect_b32 s8, s18, s20
    s_cselect_b32 s9, s19, s21
    s_cselect_b32 s45, 0, 9
    s_sub_u32 s46, s46, s45
    s_lshl_b32 s46, s46, 7
    s_add_u32 m0, s48, 51200
    s_nop 0
    buffer_load_dwordx4 v8, s[8:11], s46 offen offset:0 lds
    s_add_u32 m0, s48, 51200
    s_nop 0
    buffer_load_dwordx4 v9, s[8:11], s46 offen offset:2048 lds
    s_add_u32 m0, s48, 55296
    s_nop 0
    buffer_load_dwordx4 v10, s[8:11], s46 offen offset:0 lds
    s_add_u32 m0, s48, 55296
    s_nop 0
    buffer_load_dwordx4 v11, s[8:11], s46 offen offset:2048 lds
    s_add_u32 m0, s48, 59392
    s_nop 0
    buffer_load_dwordx4 v12, s[8:11], s46 offen offset:0 lds
    s_waitcnt vmcnt(23)
    s_barrier
    s_add_u32 m0, s48, 59392
    s_nop 0
    buffer_load_dwordx4 v13, s[8:11], s46 offen offset:2048 lds
    s_add_u32 m0, s48, 63488
    s_nop 0
    buffer_load_dwordx4 v14, s[8:11], s46 offen offset:0 lds
    s_add_u32 m0, s48, 63488
    s_nop 0
    buffer_load_dwordx4 v15, s[8:11], s46 offen offset:2048 lds
    s_add_u32 m0, s48, 67584
    s_nop 0
    buffer_load_dwordx4 v16, s[8:11], s46 offen offset:0 lds
    s_add_u32 s46, s66, 14
    s_cmp_ge_u32 s46, 18
    s_cselect_b32 s45, 18, 0
    s_sub_u32 s46, s46, s45
    s_cmp_lt_u32 s46, 9
    s_cselect_b32 s8, s18, s20
    s_cselect_b32 s9, s19, s21
    s_cselect_b32 s45, 0, 9
    s_sub_u32 s46, s46, s45
    s_lshl_b32 s46, s46, 7
    s_add_u32 m0, s48, 69632
    s_nop 0
    buffer_load_dwordx4 v8, s[8:11], s46 offen offset:0 lds
    s_add_u32 m0, s48, 69632
    s_nop 0
    buffer_load_dwordx4 v9, s[8:11], s46 offen offset:2048 lds
    s_add_u32 m0, s48, 73728
    s_nop 0
    buffer_load_dwordx4 v10, s[8:11], s46 offen offset:0 lds
    s_waitcnt vmcnt(21)
    s_barrier
    s_add_u32 m0, s48, 73728
    s_nop 0
    buffer_load_dwordx4 v11, s[8:11], s46 offen offset:2048 lds
    s_add_u32 m0, s48, 77824
    s_nop 0
    buffer_load_dwordx4 v12, s[8:11], s46 offen offset:0 lds
    s_add_u32 m0, s48, 77824
    s_nop 0
    buffer_load_dwordx4 v13, s[8:11], s46 offen offset:2048 lds
    s_add_u32 m0, s48, 81920
    s_nop 0
    buffer_load_dwordx4 v14, s[8:11], s46 offen offset:0 lds
    s_add_u32 m0, s48, 81920
    s_nop 0
    buffer_load_dwordx4 v15, s[8:11], s46 offen offset:2048 lds
    s_add_u32 m0, s48, 86016
    s_nop 0
    buffer_load_dwordx4 v16, s[8:11], s46 offen offset:0 lds
    s_add_u32 s46, s66, 15
    s_cmp_ge_u32 s46, 18
    s_cselect_b32 s45, 18, 0
    s_sub_u32 s46, s46, s45
    s_cmp_lt_u32 s46, 9
    s_cselect_b32 s8, s18, s20
    s_cselect_b32 s9, s19, s21
    s_cselect_b32 s45, 0, 9
    s_sub_u32 s46, s46, s45
    s_lshl_b32 s46, s46, 7
    s_add_u32 m0, s48, 88064
    s_nop 0
    buffer_load_dwordx4 v8, s[8:11], s46 offen offset:0 lds
    s_add_u32 m0, s48, 88064
    s_nop 0
    buffer_load_dwordx4 v9, s[8:11], s46 offen offset:2048 lds
    s_waitcnt vmcnt(20)
    s_barrier
    s_add_u32 m0, s48, 92160
    s_nop 0
    buffer_load_dwordx4 v10, s[8:11], s46 offen offset:0 lds
    s_add_u32 m0, s48, 92160
    s_nop 0
    buffer_load_dwordx4 v11, s[8:11], s46 offen offset:2048 lds
    s_add_u32 m0, s48, 96256
    s_nop 0
    buffer_load_dwordx4 v12, s[8:11], s46 offen offset:0 lds
    s_add_u32 m0, s48, 96256
    s_nop 0
    buffer_load_dwordx4 v13, s[8:11], s46 offen offset:2048 lds
    s_add_u32 m0, s48, 100352
    s_nop 0
    buffer_load_dwordx4 v14, s[8:11], s46 offen offset:0 lds
    s_add_u32 m0, s48, 100352
    s_nop 0
    buffer_load_dwordx4 v15, s[8:11], s46 offen offset:2048 lds
    s_add_u32 m0, s48, 104448
    s_nop 0
    buffer_load_dwordx4 v16, s[8:11], s46 offen offset:0 lds
    s_waitcnt vmcnt(18)
    s_barrier
    s_add_u32 s46, s66, 16
    s_cmp_ge_u32 s46, 18
    s_cselect_b32 s45, 18, 0
    s_sub_u32 s46, s46, s45
    s_cmp_lt_u32 s46, 9
    s_cselect_b32 s8, s18, s20
    s_cselect_b32 s9, s19, s21
    s_cselect_b32 s45, 0, 9
    s_sub_u32 s46, s46, s45
    s_lshl_b32 s46, s46, 7
    s_add_u32 m0, s48, 106496
    s_nop 0
    buffer_load_dwordx4 v8, s[8:11], s46 offen offset:0 lds
    s_add_u32 m0, s48, 106496
    s_nop 0
    buffer_load_dwordx4 v9, s[8:11], s46 offen offset:2048 lds
    s_add_u32 m0, s48, 110592
    s_nop 0
    buffer_load_dwordx4 v10, s[8:11], s46 offen offset:0 lds
    s_add_u32 m0, s48, 110592
    s_nop 0
    buffer_load_dwordx4 v11, s[8:11], s46 offen offset:2048 lds
    s_add_u32 m0, s48, 114688
    s_nop 0
    buffer_load_dwordx4 v12, s[8:11], s46 offen offset:0 lds
    s_add_u32 m0, s48, 114688
    s_nop 0
    buffer_load_dwordx4 v13, s[8:11], s46 offen offset:2048 lds
    s_add_u32 m0, s48, 118784
    s_nop 0
    buffer_load_dwordx4 v14, s[8:11], s46 offen offset:0 lds
    s_add_u32 m0, s48, 118784
    s_nop 0
    buffer_load_dwordx4 v15, s[8:11], s46 offen offset:2048 lds
    s_waitcnt vmcnt(17)
    s_barrier
    s_add_u32 m0, s48, 122880
    s_nop 0
    buffer_load_dwordx4 v16, s[8:11], s46 offen offset:0 lds
    s_add_u32 s46, s66, 17
    s_cmp_ge_u32 s46, 18
    s_cselect_b32 s45, 18, 0
    s_sub_u32 s46, s46, s45
    s_cmp_lt_u32 s46, 9
    s_cselect_b32 s8, s18, s20
    s_cselect_b32 s9, s19, s21
    s_cselect_b32 s45, 0, 9
    s_sub_u32 s46, s46, s45
    s_lshl_b32 s46, s46, 7
    s_add_u32 m0, s48, 124928
    s_nop 0
    buffer_load_dwordx4 v8, s[8:11], s46 offen offset:0 lds
    s_add_u32 m0, s48, 124928
    s_nop 0
    buffer_load_dwordx4 v9, s[8:11], s46 offen offset:2048 lds
    s_add_u32 m0, s48, 129024
    s_nop 0
    buffer_load_dwordx4 v10, s[8:11], s46 offen offset:0 lds
    s_add_u32 m0, s48, 129024
    s_nop 0
    buffer_load_dwordx4 v11, s[8:11], s46 offen offset:2048 lds
    s_add_u32 m0, s48, 133120
    s_nop 0
    buffer_load_dwordx4 v12, s[8:11], s46 offen offset:0 lds
    s_add_u32 m0, s48, 133120
    s_nop 0
    buffer_load_dwordx4 v13, s[8:11], s46 offen offset:2048 lds
    s_waitcnt vmcnt(15)
    s_barrier
    s_add_u32 m0, s48, 137216
    s_nop 0
    buffer_load_dwordx4 v14, s[8:11], s46 offen offset:0 lds
    s_add_u32 m0, s48, 137216
    s_nop 0
    buffer_load_dwordx4 v15, s[8:11], s46 offen offset:2048 lds
    s_add_u32 m0, s48, 141312
    s_nop 0
    buffer_load_dwordx4 v16, s[8:11], s46 offen offset:0 lds
    s_waitcnt vmcnt(9)
    s_barrier
    s_waitcnt vmcnt(0)
    s_barrier
    s_endpgm
L_cap:
    v_add_u32 v200, s53, v202
    s_add_u32 s55, s52, -9
    s_cmp_lt_u32 s55, 8
    s_cbranch_scc0 Lcp_9
    s_lshl_b32 s55, s55, 4
    v_xor_b32 v201, s55, v200
    ds_read_b128 v[108:111], v201
Lcp_9:
    s_add_u32 s55, s52, -8
    s_cmp_lt_u32 s55, 8
    s_cbranch_scc0 Lcp_10
    s_lshl_b32 s55, s55, 4
    v_xor_b32 v201, s55, v200
    ds_read_b128 v[112:115], v201
Lcp_10:
    s_add_u32 s55, s52, -7
    s_cmp_lt_u32 s55, 8
    s_cbranch_scc0 Lcp_11
    s_lshl_b32 s55, s55, 4
    v_xor_b32 v201, s55, v200
    ds_read_b128 v[116:119], v201
Lcp_11:
    s_add_u32 s55, s52, -6
    s_cmp_lt_u32 s55, 8
    s_cbranch_scc0 Lcp_12
    s_lshl_b32 s55, s55, 4
    v_xor_b32 v201, s55, v200
    ds_read_b128 v[120:123], v201
Lcp_12:
    s_add_u32 s55, s52, -5
    s_cmp_lt_u32 s55, 8
    s_cbranch_scc0 Lcp_13
    s_lshl_b32 s55, s55, 4
    v_xor_b32 v201, s55, v200
    ds_read_b128 v[124:127], v201
Lcp_13:
    s_add_u32 s55, s52, -4
    s_cmp_lt_u32 s55, 8
    s_cbranch_scc0 Lcp_14
    s_lshl_b32 s55, s55, 4
    v_xor_b32 v201, s55, v200
    ds_read_b128 v[128:131], v201
Lcp_14:
    s_add_u32 s55, s52, -3
    s_cmp_lt_u32 s55, 8
    s_cbranch_scc0 Lcp_15
    s_lshl_b32 s55, s55, 4
    v_xor_b32 v201, s55, v200
    ds_read_b128 v[132:135], v201
Lcp_15:
    s_add_u32 s55, s52, -2
    s_cmp_lt_u32 s55, 8
    s_cbranch_scc0 Lcp_16
    s_lshl_b32 s55, s55, 4
    v_xor_b32 v201, s55, v200
    ds_read_b128 v[136:139], v201
Lcp_16:
    s_add_u32 s55, s52, -1
    s_cmp_lt_u32 s55, 8
    s_cbranch_scc0 Lcp_17
    s_lshl_b32 s55, s55, 4
    v_xor_b32 v201, s55, v200
    ds_read_b128 v[140:143], v201
Lcp_17:
    s_add_u32 s55, s52, 0
    s_cmp_lt_u32 s55, 8
    s_cbranch_scc0 Lcp_18
    s_lshl_b32 s55, s55, 4
    v_xor_b32 v201, s55, v200
    ds_read_b128 v[144:147], v201
Lcp_18:
    s_waitcnt lgkmcnt(0)
    s_setpc_b64 s[68:69]
L_aux:
    s_sub_u32 s37, s3, 6
    v_and_b32 v8, 3, v0
    v_lshlrev_b32 v8, 2, v8
    v_add_u32 v8, 155456, v8
    v_and_b32 v9, 1, v0
    v_lshlrev_b32 v9, 2, v9
    v_add_u32 v9, 155456, v9
    v_mov_b32 v4, 155456
    s_mul_i32 s40, s37, 36
    v_add_u32 v1, s40, v0
    s_mul_i32 s41, s6, 72
    v_add_u32 v2, s41, v1
    v_lshlrev_b32 v2, 1, v2
    s_waitcnt lgkmcnt(0)
    s_mov_b32 s44, s10
    s_mov_b32 s45, s11
    s_mov_b32 s46, 1152
    s_mov_b32 s47, 0x20000
    s_mov_b32 s48, s12
    s_mov_b32 s49, s13
    s_mov_b32 s50, 1152
    s_mov_b32 s51, 0x20000
    s_mov_b32 s52, s22
    s_mov_b32 s53, s23
    s_mov_b32 s54, 1152
    s_mov_b32 s55, 0x20000
    buffer_load_ushort v10, v2, s[44:47], 0 offen
    buffer_load_ushort v11, v2, s[48:51], 0 offen
    buffer_load_ushort v12, v2, s[52:55], 0 offen
    s_mov_b32 s60, s28
    s_mov_b32 s61, s29
    s_mov_b32 s62, 256
    s_mov_b32 s63, 0x20000
    s_cmp_ge_u32 s2, 8
    s_cbranch_scc1 Lnn_19
    s_cmp_lg_u32 s3, 7
    s_cbranch_scc1 Lnn_19
    s_memrealtime s[40:41]
    s_waitcnt lgkmcnt(0)
    s_lshl_b32 s40, s40, 4
    s_or_b32 s40, s40, 0x80000000
    v_mov_b32 v40, s40
    v_mov_b32 v41, 0
    s_mov_b64 exec, 1
    buffer_atomic_cmpswap v[40:41], v41, s[60:63], 0 offen sc1
    s_mov_b64 exec, -1
Lnn_19:
    s_lshl_b32 s40, s32, 8
    s_add_u32 s40, s40, 11534336
    s_add_u32 s24, s30, s40
    s_addc_u32 s25, s31, 0
    s_mov_b32 s26, 256
    s_mov_b32 s27, 0x20000
    s_lshl_b32 s40, s4, 3
    s_add_u32 s40, s40, s6
    s_mul_i32 s40, s40, 18432
    s_add_u32 s40, s40, 10485760
    s_add_u32 s64, s30, s40
    s_addc_u32 s65, s31, 0
    s_mov_b32 s66, 18432
    s_mov_b32 s67, 0x20000
    s_mul_i32 s40, s32, 294912
    s_add_u32 s56, s30, s40
    s_addc_u32 s57, s31, 0
    s_mov_b32 s58, 294912
    s_mov_b32 s59, 0x20000
    s_mul_i32 s40, s6, 4608
    s_mul_i32 s41, s37, 73728
    s_add_u32 s40, s40, s41
    v_lshlrev_b32 v226, 7, v0
    v_add_u32 v226, s40, v226
    s_add_u32 s54, s35, s6
    s_mul_i32 s55, s54, 11
    s_lshr_b32 s55, s55, 5
    s_mul_i32 s55, s55, 3
    s_sub_u32 s54, s54, s55
    s_mul_i32 s54, s54, 3
    s_add_u32 s54, s54, s36
    s_cmp_ge_u32 s54, 9
    s_cselect_b32 s55, 9, 0
    s_sub_u32 s54, s54, s55
    s_and_b32 s52, s6, 3
    s_mul_i32 s52, s52, 18
    s_mul_i32 s55, s37, 10
    s_add_u32 s70, s52, s55
    s_add_u32 s70, s70, 9
    s_lshl_b32 s54, s54, 3
    v_bfe_u32 v200, v0, 3, 2
    v_and_b32 v201, 1, v0
    v_lshl_add_u32 v202, v200, 1, v201
    v_bfe_u32 v203, v0, 2, 1
    v_lshl_add_u32 v203, v202, 1, v203
    v_lshlrev_b32 v202, 4, v202
    v_lshl_add_u32 v202, v203, 7, v202
    v_bfe_u32 v203, v0, 1, 1
    v_lshl_add_u32 v202, v203, 11, v202
    v_lshrrev_b32 v203, 5, v0
    v_lshl_add_u32 v202, v203, 12, v202
    s_lshr_b32 s55, s6, 2
    s_lshl_b32 s55, s55, 13
    v_add_u32 v202, s55, v202
    s_mul_i32 s40, s5, 1152
    v_lshlrev_b32 v28, 4, v1
    v_add_u32 v28, s40, v28
    v_subrev_u32 v230, 1152, v28
    s_cmp_ge_u32 s5, 1
    s_cselect_b32 s41, 0, 0x80000000
    v_or_b32 v230, s41, v230
    v_subrev_u32 v231, 2304, v28
    s_cmp_ge_u32 s5, 2
    s_cselect_b32 s41, 0, 0x80000000
    v_or_b32 v231, s41, v231
    v_subrev_u32 v232, 3456, v28
    s_cmp_ge_u32 s5, 3
    s_cselect_b32 s41, 0, 0x80000000
    v_or_b32 v232, s41, v232
    v_subrev_u32 v233, 4608, v28
    s_cmp_ge_u32 s5, 4
    s_cselect_b32 s41, 0, 0x80000000
    v_or_b32 v233, s41, v233
    v_subrev_u32 v234, 5760, v28
    s_cmp_ge_u32 s5, 5
    s_cselect_b32 s41, 0, 0x80000000
    v_or_b32 v234, s41, v234
    v_subrev_u32 v235, 6912, v28
    s_cmp_ge_u32 s5, 6
    s_cselect_b32 s41, 0, 0x80000000
    v_or_b32 v235, s41, v235
    v_subrev_u32 v236, 8064, v28
    s_cmp_ge_u32 s5, 7
    s_cselect_b32 s41, 0, 0x80000000
    v_or_b32 v236, s41, v236
    v_subrev_u32 v237, 9216, v28
    s_cmp_ge_u32 s5, 8
    s_cselect_b32 s41, 0, 0x80000000
    v_or_b32 v237, s41, v237
    v_subrev_u32 v238, 10368, v28
    s_cmp_ge_u32 s5, 9
    s_cselect_b32 s41, 0, 0x80000000
    v_or_b32 v238, s41, v238
    v_subrev_u32 v239, 11520, v28
    s_cmp_ge_u32 s5, 10
    s_cselect_b32 s41, 0, 0x80000000
    v_or_b32 v239, s41, v239
    v_subrev_u32 v240, 12672, v28
    s_cmp_ge_u32 s5, 11
    s_cselect_b32 s41, 0, 0x80000000
    v_or_b32 v240, s41, v240
    v_subrev_u32 v241, 13824, v28
    s_cmp_ge_u32 s5, 12
    s_cselect_b32 s41, 0, 0x80000000
    v_or_b32 v241, s41, v241
    v_subrev_u32 v242, 14976, v28
    s_cmp_ge_u32 s5, 13
    s_cselect_b32 s41, 0, 0x80000000
    v_or_b32 v242, s41, v242
    v_subrev_u32 v243, 16128, v28
    s_cmp_ge_u32 s5, 14
    s_cselect_b32 s41, 0, 0x80000000
    v_or_b32 v243, s41, v243
    v_subrev_u32 v244, 17280, v28
    s_cmp_ge_u32 s5, 15
    s_cselect_b32 s41, 0, 0x80000000
    v_or_b32 v244, s41, v244
    v_lshlrev_b32 v61, 3, v1
    v_add_u32 v61, 154880, v61
    v_lshlrev_b32 v63, 3, v1
    v_add_u32 v63, 145664, v63
    s_mul_i32 s40, s5, 1152
    v_lshlrev_b32 v64, 4, v1
    v_add_u32 v64, s40, v64
    v_and_b32 v66, 7, v0
    v_lshlrev_b32 v66, 2, v66
    v_add_u32 v66, 128, v66
    s_barrier
    s_sub_u32 s52, s70, s54
    s_cmp_lt_u32 s52, 17
    s_cbranch_scc0 Lcs_20
    s_mov_b32 s53, 0
    s_call_b64 s[68:69], L_cap
Lcs_20:
    s_add_u32 s54, s54, 8
    s_cmp_ge_u32 s54, 72
    s_cselect_b32 s54, 0, s54
    s_barrier
    s_sub_u32 s52, s70, s54
    s_cmp_lt_u32 s52, 17
    s_cbranch_scc0 Lcs_21
    s_mov_b32 s53, 34816
    s_call_b64 s[68:69], L_cap
Lcs_21:
    s_add_u32 s54, s54, 8
    s_cmp_ge_u32 s54, 72
    s_cselect_b32 s54, 0, s54
    s_waitcnt vmcnt(0)
    v_lshlrev_b32 v10, 16, v10
    v_lshlrev_b32 v11, 16, v11
    v_lshlrev_b32 v12, 16, v12
    v_mul_f32 v12, 0x3fb8aa3b, v12
    v_exp_f32 v12, v12
    s_nop 0
    v_cvt_pk_bf16_f32 v12, v12, v12
    v_lshlrev_b32 v12, 16, v12
    v_mul_f32 v13, v12, v10
    v_mul_f32 v14, v12, v11
    v_mul_f32 v16, 0x3fb8aa3b, v13
    v_mul_f32 v17, 0x3e22f983, v14
    v_exp_f32 v18, v16
    v_fract_f32 v19, v17
    v_sin_f32 v13, v19
    v_cos_f32 v14, v19
    s_nop 0
    v_mul_f32 v20, v18, v14
    v_mul_f32 v21, v18, v13
    v_subrev_f32 v28, 1.0, v20
    v_mul_f32 v29, v10, v10
    v_fmac_f32 v29, v11, v11
    v_rcp_f32 v30, v29
    v_mul_f32 v31, v28, v10
    v_fmac_f32 v31, v21, v11
    v_mul_f32 v32, v21, v10
    v_fma_f32 v32, -v28, v11, v32
    v_fma_f32 v33, -v29, v30, 2.0
    v_mul_f32 v30, v30, v33
    v_add_f32 v30, v30, v30
    v_mul_f32 v22, v31, v30
    v_mul_f32 v23, v32, v30
    v_mul_f32 v28, 4.0, v16
    v_mul_f32 v29, 4.0, v17
    v_exp_f32 v28, v28
    v_fract_f32 v29, v29
    v_cos_f32 v18, v29
    v_sin_f32 v19, v29
    v_lshlrev_b32 v5, 4, v1
    v_mul_f32 v18, v28, v18
    v_mul_f32 v19, v28, v19
    v_add_u32 v5, 143360, v5
    s_mov_b32 exec_hi, 0xf
    ds_write_b128 v5, v[20:23]
    ds_write_b128 v5, v[16:19] offset:1152
    s_mov_b64 exec, -1
    s_lshl_b32 s40, s37, 2
    v_add_u32 v35, s40, v4
    v_mov_b32 v36, 1
    v_mul_f32 v28, 0x41000000, v16
    v_mul_f32 v29, 0x41000000, v17
    v_min_f32 v28, 0x42fc0000, v28
    v_exp_f32 v28, v28
    v_fract_f32 v29, v29
    v_cos_f32 v40, v29
    v_sin_f32 v41, v29
    s_nop 0
    v_mul_f32 v40, v28, v40
    v_mul_f32 v41, -v28, v41
    s_waitcnt lgkmcnt(0)
    s_barrier
    s_sub_u32 s52, s70, s54
    s_cmp_lt_u32 s52, 17
    s_cbranch_scc0 Lcs_22
    s_mov_b32 s53, 69632
    s_call_b64 s[68:69], L_cap
Lcs_22:
    s_add_u32 s54, s54, 8
    s_cmp_ge_u32 s54, 72
    s_cselect_b32 s54, 0, s54
    v_mul_f32 v32, 0x43800000, v16
    v_mul_f32 v33, 0x43800000, v17
    v_min_f32 v32, 0x42fc0000, v32
    v_exp_f32 v32, v32
    v_fract_f32 v33, v33
    v_cos_f32 v46, v33
    v_sin_f32 v47, v33
    s_nop 0
    v_mul_f32 v46, v32, v46
    v_mul_f32 v47, -v32, v47
    v_mul_f32 v32, 0x43000000, v16
    v_mul_f32 v33, 0x43000000, v17
    v_min_f32 v32, 0x42fc0000, v32
    v_exp_f32 v32, v32
    v_fract_f32 v33, v33
    v_cos_f32 v48, v33
    v_sin_f32 v49, v33
    s_nop 0
    v_mul_f32 v48, v32, v48
    v_mul_f32 v49, -v32, v49
    s_load_dwordx2 s[100:101], s[24:25], 60
    s_barrier
    s_sub_u32 s52, s70, s54
    s_cmp_lt_u32 s52, 17
    s_cbranch_scc0 Lcs_23
    s_mov_b32 s53, 0
    s_call_b64 s[68:69], L_cap
Lcs_23:
    s_add_u32 s54, s54, 8
    s_cmp_ge_u32 s54, 72
    s_cselect_b32 s54, 0, s54
    s_load_dword s73, s[28:29], 0
    s_barrier
    s_sub_u32 s52, s70, s54
    s_cmp_lt_u32 s52, 17
    s_cbranch_scc0 Lcs_24
    s_mov_b32 s53, 34816
    s_call_b64 s[68:69], L_cap
Lcs_24:
    s_add_u32 s54, s54, 8
    s_cmp_ge_u32 s54, 72
    s_cselect_b32 s54, 0, s54
    s_barrier
    s_sub_u32 s52, s70, s54
    s_cmp_lt_u32 s52, 17
    s_cbranch_scc0 Lcs_25
    s_mov_b32 s53, 69632
    s_call_b64 s[68:69], L_cap
Lcs_25:
    s_add_u32 s54, s54, 8
    s_cmp_ge_u32 s54, 72
    s_cselect_b32 s54, 0, s54
    s_waitcnt lgkmcnt(0)
    s_mov_b32 s16, s73
    s_cmp_lg_u32 s16, 0
    s_cbranch_scc1 L_nonce_ok
    s_mov_b32 s40, 0
    v_mov_b32 v28, 0
L_nonce_poll:
    buffer_load_dword v29, v28, s[60:63], 0 offen sc0 sc1
    s_waitcnt vmcnt(0)
    v_readfirstlane_b32 s16, v29
    s_add_u32 s40, s40, 1
    s_cmp_ge_u32 s40, 65536
    s_cbranch_scc1 L_nonce_ok
    s_cmp_eq_u32 s16, 0
    s_cbranch_scc1 L_nonce_poll
L_nonce_ok:
    s_getreg_b32 s17, hwreg(HW_REG_XCC_ID, 0, 4)
    s_or_b32 s17, s17, s16
    v_mov_b32 v28, s17
    s_lshl_b32 s40, s6, 2
    s_add_u32 s40, s40, 128
    v_mov_b32 v29, s40
    s_mov_b64 exec, 1
    buffer_store_dword v28, v29, s[24:27], 0 offen sc1
    s_mov_b64 exec, -1
    s_cmp_ge_u32 s5, 1
    s_cselect_b32 s8, s16, 0
    s_cmp_ge_u32 s5, 2
    s_cselect_b32 s9, s16, 0
    s_cmp_ge_u32 s5, 3
    s_cselect_b32 s10, s16, 0
    s_cmp_ge_u32 s5, 4
    s_cselect_b32 s11, s16, 0
    s_cmp_ge_u32 s5, 5
    s_cselect_b32 s12, s16, 0
    s_cmp_ge_u32 s5, 6
    s_cselect_b32 s13, s16, 0
    s_cmp_ge_u32 s5, 7
    s_cselect_b32 s14, s16, 0
    s_cmp_ge_u32 s5, 8
    s_cselect_b32 s15, s16, 0
    s_cmp_ge_u32 s5, 9
    s_cselect_b32 s18, s16, 0
    s_cmp_ge_u32 s5, 10
    s_cselect_b32 s19, s16, 0
    s_cmp_ge_u32 s5, 11
    s_cselect_b32 s20, s16, 0
    s_cmp_ge_u32 s5, 12
    s_cselect_b32 s21, s16, 0
    s_cmp_ge_u32 s5, 13
    s_cselect_b32 s22, s16, 0
    s_cmp_ge_u32 s5, 14
    s_cselect_b32 s23, s16, 0
    s_cmp_ge_u32 s5, 15
    s_cselect_b32 s44, s16, 0
    v_mov_b32 v101, s16
    v_mov_b32 v103, s16
    v_mov_b32 v42, v41
    v_sub_f32 v43, 0, v41
    v_mov_b32 v41, v40
    s_barrier
    s_sub_u32 s52, s70, s54
    s_cmp_lt_u32 s52, 17
    s_cbranch_scc0 Lcs_26
    s_mov_b32 s53, 0
    s_call_b64 s[68:69], L_cap
Lcs_26:
    s_add_u32 s54, s54, 8
    s_cmp_ge_u32 s54, 72
    s_cselect_b32 s54, 0, s54
    s_barrier
    s_mov_b32 exec_hi, 0xf
    s_mov_b32 s41, 0
    buffer_load_dword v65, v226, s[56:59], s41 offen sc1
    s_mov_b32 s41, 147456
    buffer_load_dword v65, v226, s[56:59], s41 offen sc1
    s_mov_b32 s41, 36864
    buffer_load_dword v65, v226, s[56:59], s41 offen sc1
    s_mov_b32 s41, 184320
    buffer_load_dword v65, v226, s[56:59], s41 offen sc1
    s_mov_b64 exec, -1
    s_sub_u32 s52, s70, s54
    s_cmp_lt_u32 s52, 17
    s_cbranch_scc0 Lcs_27
    s_mov_b32 s53, 34816
    s_call_b64 s[68:69], L_cap
Lcs_27:
    s_add_u32 s54, s54, 8
    s_cmp_ge_u32 s54, 72
    s_cselect_b32 s54, 0, s54
    s_barrier
    s_sub_u32 s52, s70, s54
    s_cmp_lt_u32 s52, 17
    s_cbranch_scc0 Lcs_28
    s_mov_b32 s53, 69632
    s_call_b64 s[68:69], L_cap
Lcs_28:
    s_mul_i32 s40, s37, 10240
    s_add_u32 s40, s40, 104448
    v_mul_u32_u24 v200, 160, v0
    v_add_u32 v200, s40, v200
    ds_write_b128 v200, v[108:111] offset:0
    ds_write_b128 v200, v[112:115] offset:16
    ds_write_b128 v200, v[116:119] offset:32
    ds_write_b128 v200, v[120:123] offset:48
    ds_write_b128 v200, v[124:127] offset:64
    ds_write_b128 v200, v[128:131] offset:80
    ds_write_b128 v200, v[132:135] offset:96
    ds_write_b128 v200, v[136:139] offset:112
    ds_write_b128 v200, v[140:143] offset:128
    ds_write_b128 v200, v[144:147] offset:144
    s_mov_b64 exec, 1
    ds_write_b32 v35, v36 offset:88
    s_mov_b64 exec, -1
    s_setprio 2
    s_mov_b32 s72, 0
Lw_29:
    ds_read_b32 v6, v8 offset:48
    s_add_u32 s72, s72, 1
    s_cmp_ge_u32 s72, 524288
    s_waitcnt lgkmcnt(0)
    v_cmp_gt_u32 vcc, 1, v6
    s_cbranch_vccz Lwd_30
    s_cbranch_scc1 Lwd_30
    s_sleep 1
    s_branch Lw_29
Lwd_30:
    s_setprio 3
    s_mov_b32 exec_hi, 0xf
    ds_read_b64 v[68:69], v63 offset:0
    ds_read_b64 v[70:71], v63 offset:576
    ds_read_b64 v[72:73], v63 offset:1152
    ds_read_b64 v[74:75], v63 offset:1728
    ds_read_b64 v[76:77], v63 offset:2304
    ds_read_b64 v[78:79], v63 offset:2880
    ds_read_b64 v[80:81], v63 offset:3456
    ds_read_b64 v[82:83], v63 offset:4032
    ds_read_b64 v[84:85], v63 offset:4608
    ds_read_b64 v[86:87], v63 offset:5184
    ds_read_b64 v[88:89], v63 offset:5760
    ds_read_b64 v[90:91], v63 offset:6336
    ds_read_b64 v[92:93], v63 offset:6912
    ds_read_b64 v[94:95], v63 offset:7488
    ds_read_b64 v[96:97], v63 offset:8064
    ds_read_b64 v[98:99], v63 offset:8640
    s_waitcnt lgkmcnt(14)
    v_pk_fma_f32 v[70:71], v[40:41], v[68:69], v[70:71]
    v_pk_fma_f32 v[70:71], v[42:43], v[68:69], v[70:71] op_sel:[0,1,0] op_sel_hi:[1,0,1]
    s_waitcnt lgkmcnt(13)
    v_pk_fma_f32 v[72:73], v[40:41], v[70:71], v[72:73]
    v_pk_fma_f32 v[72:73], v[42:43], v[70:71], v[72:73] op_sel:[0,1,0] op_sel_hi:[1,0,1]
    s_waitcnt lgkmcnt(12)
    v_pk_fma_f32 v[74:75], v[40:41], v[72:73], v[74:75]
    v_pk_fma_f32 v[74:75], v[42:43], v[72:73], v[74:75] op_sel:[0,1,0] op_sel_hi:[1,0,1]
    s_waitcnt lgkmcnt(11)
    v_pk_fma_f32 v[76:77], v[40:41], v[74:75], v[76:77]
    v_pk_fma_f32 v[76:77], v[42:43], v[74:75], v[76:77] op_sel:[0,1,0] op_sel_hi:[1,0,1]
    s_waitcnt lgkmcnt(10)
    v_pk_fma_f32 v[78:79], v[40:41], v[76:77], v[78:79]
    v_pk_fma_f32 v[78:79], v[42:43], v[76:77], v[78:79] op_sel:[0,1,0] op_sel_hi:[1,0,1]
    s_waitcnt lgkmcnt(9)
    v_pk_fma_f32 v[80:81], v[40:41], v[78:79], v[80:81]
    v_pk_fma_f32 v[80:81], v[42:43], v[78:79], v[80:81] op_sel:[0,1,0] op_sel_hi:[1,0,1]
    s_waitcnt lgkmcnt(8)
    v_pk_fma_f32 v[82:83], v[40:41], v[80:81], v[82:83]
    v_pk_fma_f32 v[82:83], v[42:43], v[80:81], v[82:83] op_sel:[0,1,0] op_sel_hi:[1,0,1]
    s_waitcnt lgkmcnt(7)
    v_pk_fma_f32 v[84:85], v[40:41], v[82:83], v[84:85]
    v_pk_fma_f32 v[84:85], v[42:43], v[82:83], v[84:85] op_sel:[0,1,0] op_sel_hi:[1,0,1]
    s_waitcnt lgkmcnt(6)
    v_pk_fma_f32 v[86:87], v[40:41], v[84:85], v[86:87]
    v_pk_fma_f32 v[86:87], v[42:43], v[84:85], v[86:87] op_sel:[0,1,0] op_sel_hi:[1,0,1]
    s_waitcnt lgkmcnt(5)
    v_pk_fma_f32 v[88:89], v[40:41], v[86:87], v[88:89]
    v_pk_fma_f32 v[88:89], v[42:43], v[86:87], v[88:89] op_sel:[0,1,0] op_sel_hi:[1,0,1]
    s_waitcnt lgkmcnt(4)
    v_pk_fma_f32 v[90:91], v[40:41], v[88:89], v[90:91]
    v_pk_fma_f32 v[90:91], v[42:43], v[88:89], v[90:91] op_sel:[0,1,0] op_sel_hi:[1,0,1]
    s_waitcnt lgkmcnt(3)
    v_pk_fma_f32 v[92:93], v[40:41], v[90:91], v[92:93]
    v_pk_fma_f32 v[92:93], v[42:43], v[90:91], v[92:93] op_sel:[0,1,0] op_sel_hi:[1,0,1]
    s_waitcnt lgkmcnt(2)
    v_pk_fma_f32 v[94:95], v[40:41], v[92:93], v[94:95]
    v_pk_fma_f32 v[94:95], v[42:43], v[92:93], v[94:95] op_sel:[0,1,0] op_sel_hi:[1,0,1]
    s_waitcnt lgkmcnt(1)
    v_pk_fma_f32 v[96:97], v[40:41], v[94:95], v[96:97]
    v_pk_fma_f32 v[96:97], v[42:43], v[94:95], v[96:97] op_sel:[0,1,0] op_sel_hi:[1,0,1]
    s_waitcnt lgkmcnt(0)
    v_pk_fma_f32 v[98:99], v[40:41], v[96:97], v[98:99]
    v_pk_fma_f32 v[98:99], v[42:43], v[96:97], v[98:99] op_sel:[0,1,0] op_sel_hi:[1,0,1]
    v_mul_f32 v100, v22, v98
    v_mul_f32 v102, -v22, v99
    v_fma_f32 v100, -v23, v99, v100
    v_fma_f32 v102, -v23, v98, v102
    buffer_store_dwordx4 v[100:103], v64, s[64:67], 0 offen sc1
    v_mov_b32 v28, 0
    v_mov_b32 v29, 0
    ds_write_b64 v63, v[28:29]
    v_pk_mul_f32 v[170:171], v[22:23], v[68:69] op_sel:[0,0] op_sel_hi:[0,1] neg_hi:[0,1]
    v_pk_mul_f32 v[172:173], v[22:23], v[70:71] op_sel:[0,0] op_sel_hi:[0,1] neg_hi:[0,1]
    v_pk_mul_f32 v[174:175], v[22:23], v[72:73] op_sel:[0,0] op_sel_hi:[0,1] neg_hi:[0,1]
    v_pk_mul_f32 v[176:177], v[22:23], v[74:75] op_sel:[0,0] op_sel_hi:[0,1] neg_hi:[0,1]
    v_pk_mul_f32 v[178:179], v[22:23], v[76:77] op_sel:[0,0] op_sel_hi:[0,1] neg_hi:[0,1]
    v_pk_mul_f32 v[180:181], v[22:23], v[78:79] op_sel:[0,0] op_sel_hi:[0,1] neg_hi:[0,1]
    v_pk_mul_f32 v[182:183], v[22:23], v[80:81] op_sel:[0,0] op_sel_hi:[0,1] neg_hi:[0,1]
    v_pk_mul_f32 v[184:185], v[22:23], v[82:83] op_sel:[0,0] op_sel_hi:[0,1] neg_hi:[0,1]
    v_pk_mul_f32 v[186:187], v[22:23], v[84:85] op_sel:[0,0] op_sel_hi:[0,1] neg_hi:[0,1]
    v_pk_mul_f32 v[188:189], v[22:23], v[86:87] op_sel:[0,0] op_sel_hi:[0,1] neg_hi:[0,1]
    v_pk_mul_f32 v[190:191], v[22:23], v[88:89] op_sel:[0,0] op_sel_hi:[0,1] neg_hi:[0,1]
    v_pk_mul_f32 v[192:193], v[22:23], v[90:91] op_sel:[0,0] op_sel_hi:[0,1] neg_hi:[0,1]
    v_pk_mul_f32 v[194:195], v[22:23], v[92:93] op_sel:[0,0] op_sel_hi:[0,1] neg_hi:[0,1]
    v_pk_mul_f32 v[196:197], v[22:23], v[94:95] op_sel:[0,0] op_sel_hi:[0,1] neg_hi:[0,1]
    v_pk_mul_f32 v[198:199], v[22:23], v[96:97] op_sel:[0,0] op_sel_hi:[0,1] neg_hi:[0,1]
    v_pk_fma_f32 v[170:171], v[22:23], v[68:69], v[170:171] op_sel:[1,1,0] op_sel_hi:[1,0,1] neg_lo:[1,0,0] neg_hi:[1,0,0]
    ds_write_b64 v63, v[170:171] offset:576
    v_pk_fma_f32 v[172:173], v[22:23], v[70:71], v[172:173] op_sel:[1,1,0] op_sel_hi:[1,0,1] neg_lo:[1,0,0] neg_hi:[1,0,0]
    ds_write_b64 v63, v[172:173] offset:1152
    v_pk_fma_f32 v[174:175], v[22:23], v[72:73], v[174:175] op_sel:[1,1,0] op_sel_hi:[1,0,1] neg_lo:[1,0,0] neg_hi:[1,0,0]
    ds_write_b64 v63, v[174:175] offset:1728
    v_pk_fma_f32 v[176:177], v[22:23], v[74:75], v[176:177] op_sel:[1,1,0] op_sel_hi:[1,0,1] neg_lo:[1,0,0] neg_hi:[1,0,0]
    ds_write_b64 v63, v[176:177] offset:2304
    v_pk_fma_f32 v[178:179], v[22:23], v[76:77], v[178:179] op_sel:[1,1,0] op_sel_hi:[1,0,1] neg_lo:[1,0,0] neg_hi:[1,0,0]
    ds_write_b64 v63, v[178:179] offset:2880
    v_pk_fma_f32 v[180:181], v[22:23], v[78:79], v[180:181] op_sel:[1,1,0] op_sel_hi:[1,0,1] neg_lo:[1,0,0] neg_hi:[1,0,0]
    ds_write_b64 v63, v[180:181] offset:3456
    v_pk_fma_f32 v[182:183], v[22:23], v[80:81], v[182:183] op_sel:[1,1,0] op_sel_hi:[1,0,1] neg_lo:[1,0,0] neg_hi:[1,0,0]
    ds_write_b64 v63, v[182:183] offset:4032
    v_pk_fma_f32 v[184:185], v[22:23], v[82:83], v[184:185] op_sel:[1,1,0] op_sel_hi:[1,0,1] neg_lo:[1,0,0] neg_hi:[1,0,0]
    ds_write_b64 v63, v[184:185] offset:4608
    v_pk_fma_f32 v[186:187], v[22:23], v[84:85], v[186:187] op_sel:[1,1,0] op_sel_hi:[1,0,1] neg_lo:[1,0,0] neg_hi:[1,0,0]
    ds_write_b64 v63, v[186:187] offset:5184
    v_pk_fma_f32 v[188:189], v[22:23], v[86:87], v[188:189] op_sel:[1,1,0] op_sel_hi:[1,0,1] neg_lo:[1,0,0] neg_hi:[1,0,0]
    ds_write_b64 v63, v[188:189] offset:5760
    v_pk_fma_f32 v[190:191], v[22:23], v[88:89], v[190:191] op_sel:[1,1,0] op_sel_hi:[1,0,1] neg_lo:[1,0,0] neg_hi:[1,0,0]
    ds_write_b64 v63, v[190:191] offset:6336
    v_pk_fma_f32 v[192:193], v[22:23], v[90:91], v[192:193] op_sel:[1,1,0] op_sel_hi:[1,0,1] neg_lo:[1,0,0] neg_hi:[1,0,0]
    ds_write_b64 v63, v[192:193] offset:6912
    v_pk_fma_f32 v[194:195], v[22:23], v[92:93], v[194:195] op_sel:[1,1,0] op_sel_hi:[1,0,1] neg_lo:[1,0,0] neg_hi:[1,0,0]
    ds_write_b64 v63, v[194:195] offset:7488
    v_pk_fma_f32 v[196:197], v[22:23], v[94:95], v[196:197] op_sel:[1,1,0] op_sel_hi:[1,0,1] neg_lo:[1,0,0] neg_hi:[1,0,0]
    ds_write_b64 v63, v[196:197] offset:8064
    v_pk_fma_f32 v[198:199], v[22:23], v[96:97], v[198:199] op_sel:[1,1,0] op_sel_hi:[1,0,1] neg_lo:[1,0,0] neg_hi:[1,0,0]
    ds_write_b64 v63, v[198:199] offset:8640
    s_waitcnt vmcnt(0)
    buffer_load_dword v104, v66, s[24:27], 0 offen sc1
    buffer_load_dwordx4 v[164:167], v244, s[64:67], 0 offen sc1
    buffer_load_dwordx4 v[160:163], v243, s[64:67], 0 offen sc1
    buffer_load_dwordx4 v[156:159], v242, s[64:67], 0 offen sc1
    buffer_load_dwordx4 v[152:155], v241, s[64:67], 0 offen sc1
    buffer_load_dwordx4 v[148:151], v240, s[64:67], 0 offen sc1
    buffer_load_dwordx4 v[144:147], v239, s[64:67], 0 offen sc1
    buffer_load_dwordx4 v[140:143], v238, s[64:67], 0 offen sc1
    buffer_load_dwordx4 v[136:139], v237, s[64:67], 0 offen sc1
    buffer_load_dwordx4 v[132:135], v236, s[64:67], 0 offen sc1
    buffer_load_dwordx4 v[128:131], v235, s[64:67], 0 offen sc1
    buffer_load_dwordx4 v[124:127], v234, s[64:67], 0 offen sc1
    buffer_load_dwordx4 v[120:123], v233, s[64:67], 0 offen sc1
    buffer_load_dwordx4 v[116:119], v232, s[64:67], 0 offen sc1
    buffer_load_dwordx4 v[112:115], v231, s[64:67], 0 offen sc1
    buffer_load_dwordx4 v[108:111], v230, s[64:67], 0 offen sc1
    s_mov_b64 exec, 1
    ds_write_b32 v35, v36 offset:80
    s_mov_b32 exec_lo, -1
    s_mov_b32 exec_hi, 0xf
    s_waitcnt vmcnt(15)
    v_cmp_ne_u32 vcc, s17, v104
    s_nop 4
    s_cmp_eq_u64 vcc, 0
    s_cselect_b32 s40, 1, 0
    v_mov_b32 v104, s16
    v_mov_b32 v105, s40
    s_cmp_lg_u32 s37, 0
    s_cbranch_scc1 Lmd_31
    s_mov_b64 exec, 1
    ds_write_b64 v4, v[104:105] offset:72
    s_mov_b32 exec_lo, -1
    s_mov_b32 exec_hi, 0xf
Lmd_31:
    s_mov_b32 s40, 0
L_gather:
    v_mov_b32 v28, 0
    s_waitcnt vmcnt(14)
    v_xor_b32 v30, s44, v165
    v_xor_b32 v31, s44, v167
    v_or3_b32 v28, v28, v30, v31
    s_waitcnt vmcnt(13)
    v_xor_b32 v30, s23, v161
    v_xor_b32 v31, s23, v163
    v_or3_b32 v28, v28, v30, v31
    s_waitcnt vmcnt(12)
    v_xor_b32 v30, s22, v157
    v_xor_b32 v31, s22, v159
    v_or3_b32 v28, v28, v30, v31
    v_fmac_f32 v156, v46, v164
    v_fmac_f32 v158, v46, v166
    v_fma_f32 v156, -v47, v166, v156
    v_fmac_f32 v158, v47, v164
    s_waitcnt vmcnt(11)
    v_xor_b32 v30, s21, v153
    v_xor_b32 v31, s21, v155
    v_or3_b32 v28, v28, v30, v31
    v_fmac_f32 v152, v46, v160
    v_fmac_f32 v154, v46, v162
    v_fma_f32 v152, -v47, v162, v152
    v_fmac_f32 v154, v47, v160
    s_waitcnt vmcnt(10)
    v_xor_b32 v30, s20, v149
    v_xor_b32 v31, s20, v151
    v_or3_b32 v28, v28, v30, v31
    v_fmac_f32 v148, v46, v156
    v_fmac_f32 v150, v46, v158
    v_fma_f32 v148, -v47, v158, v148
    v_fmac_f32 v150, v47, v156
    s_waitcnt vmcnt(9)
    v_xor_b32 v30, s19, v145
    v_xor_b32 v31, s19, v147
    v_or3_b32 v28, v28, v30, v31
    v_fmac_f32 v144, v46, v152
    v_fmac_f32 v146, v46, v154
    v_fma_f32 v144, -v47, v154, v144
    v_fmac_f32 v146, v47, v152
    s_waitcnt vmcnt(8)
    v_xor_b32 v30, s18, v141
    v_xor_b32 v31, s18, v143
    v_or3_b32 v28, v28, v30, v31
    v_fmac_f32 v140, v46, v148
    v_fmac_f32 v142, v46, v150
    v_fma_f32 v140, -v47, v150, v140
    v_fmac_f32 v142, v47, v148
    s_waitcnt vmcnt(7)
    v_xor_b32 v30, s15, v137
    v_xor_b32 v31, s15, v139
    v_or3_b32 v28, v28, v30, v31
    v_fmac_f32 v136, v46, v144
    v_fmac_f32 v138, v46, v146
    v_fma_f32 v136, -v47, v146, v136
    v_fmac_f32 v138, v47, v144
    s_waitcnt vmcnt(6)
    v_xor_b32 v30, s14, v133
    v_xor_b32 v31, s14, v135
    v_or3_b32 v28, v28, v30, v31
    v_fmac_f32 v132, v46, v140
    v_fmac_f32 v134, v46, v142
    v_fma_f32 v132, -v47, v142, v132
    v_fmac_f32 v134, v47, v140
    s_waitcnt vmcnt(5)
    v_xor_b32 v30, s13, v129
    v_xor_b32 v31, s13, v131
    v_or3_b32 v28, v28, v30, v31
    v_fmac_f32 v128, v46, v136
    v_fmac_f32 v130, v46, v138
    v_fma_f32 v128, -v47, v138, v128
    v_fmac_f32 v130, v47, v136
    s_waitcnt vmcnt(4)
    v_xor_b32 v30, s12, v125
    v_xor_b32 v31, s12, v127
    v_or3_b32 v28, v28, v30, v31
    v_fmac_f32 v124, v46, v132
    v_fmac_f32 v126, v46, v134
    v_fma_f32 v124, -v47, v134, v124
    v_fmac_f32 v126, v47, v132
    s_waitcnt vmcnt(3)
    v_xor_b32 v30, s11, v121
    v_xor_b32 v31, s11, v123
    v_or3_b32 v28, v28, v30, v31
    v_fmac_f32 v120, v46, v128
    v_fmac_f32 v122, v46, v130
    v_fma_f32 v120, -v47, v130, v120
    v_fmac_f32 v122, v47, v128
    s_waitcnt vmcnt(2)
    v_xor_b32 v30, s10, v117
    v_xor_b32 v31, s10, v119
    v_or3_b32 v28, v28, v30, v31
    v_fmac_f32 v116, v46, v124
    v_fmac_f32 v118, v46, v126
    v_fma_f32 v116, -v47, v126, v116
    v_fmac_f32 v118, v47, v124
    s_waitcnt vmcnt(1)
    v_xor_b32 v30, s9, v113
    v_xor_b32 v31, s9, v115
    v_or3_b32 v28, v28, v30, v31
    v_fmac_f32 v112, v46, v120
    v_fmac_f32 v114, v46, v122
    v_fma_f32 v112, -v47, v122, v112
    v_fmac_f32 v114, v47, v120
    s_waitcnt vmcnt(0)
    v_xor_b32 v30, s8, v109
    v_xor_b32 v31, s8, v111
    v_or3_b32 v28, v28, v30, v31
    v_fmac_f32 v108, v46, v116
    v_fmac_f32 v110, v46, v118
    v_fma_f32 v108, -v47, v118, v108
    v_fmac_f32 v110, v47, v116
    v_cmp_ne_u32 vcc, 0, v28
    v_fma_f32 v30, v48, v112, v108
    v_fma_f32 v31, v48, v114, v110
    v_fma_f32 v30, -v49, v114, v30
    v_fmac_f32 v31, v49, v112
    s_cbranch_vccz L_gfin
    s_add_u32 s40, s40, 1
    s_cmp_ge_u32 s40, 65536
    s_cbranch_scc1 L_gfin
    buffer_load_dwordx4 v[164:167], v244, s[64:67], 0 offen sc1
    buffer_load_dwordx4 v[160:163], v243, s[64:67], 0 offen sc1
    buffer_load_dwordx4 v[156:159], v242, s[64:67], 0 offen sc1
    buffer_load_dwordx4 v[152:155], v241, s[64:67], 0 offen sc1
    buffer_load_dwordx4 v[148:151], v240, s[64:67], 0 offen sc1
    buffer_load_dwordx4 v[144:147], v239, s[64:67], 0 offen sc1
    buffer_load_dwordx4 v[140:143], v238, s[64:67], 0 offen sc1
    buffer_load_dwordx4 v[136:139], v237, s[64:67], 0 offen sc1
    buffer_load_dwordx4 v[132:135], v236, s[64:67], 0 offen sc1
    buffer_load_dwordx4 v[128:131], v235, s[64:67], 0 offen sc1
    buffer_load_dwordx4 v[124:127], v234, s[64:67], 0 offen sc1
    buffer_load_dwordx4 v[120:123], v233, s[64:67], 0 offen sc1
    buffer_load_dwordx4 v[116:119], v232, s[64:67], 0 offen sc1
    buffer_load_dwordx4 v[112:115], v231, s[64:67], 0 offen sc1
    buffer_load_dwordx4 v[108:111], v230, s[64:67], 0 offen sc1
    s_branch L_gather
L_gfin:
    ds_write_b64 v61, v[30:31]
    s_mov_b64 exec, 1
    ds_write_b32 v35, v36 offset:64
    s_mov_b64 exec, -1
    s_setprio 1
    s_lshr_b32 s40, s6, 2
    s_lshl_b32 s40, s40, 1
    s_add_u32 s40, s40, s37
    s_lshl_b32 s41, s40, 5
    v_lshlrev_b32 v21, 2, v0
    v_add_u32 v21, s41, v21
    s_mul_i32 s40, s40, 36864
    v_lshlrev_b32 v18, 4, v0
    v_add_u32 v18, s40, v18
    s_lshl_b32 s47, s37, 12
    s_lshl_b32 s45, s35, 2
    s_lshr_b32 s41, s6, 2
    s_add_u32 s45, s45, s41
    s_add_u32 s45, s45, s36
    v_mov_b32 v36, 0
    s_sleep 8
    s_mov_b32 s40, 0
    s_mov_b64 exec, 0xff
L_fpoll:
    buffer_load_dword v24, v21, s[24:27], 0 offen sc1
    s_waitcnt vmcnt(0)
    v_cmp_ne_u32 vcc, s16, v24
    s_add_u32 s40, s40, 1
    s_cmp_ge_u32 s40, 65536
    s_cbranch_scc1 L_fpoll_done
    s_nop 2
    s_cbranch_vccz L_fpoll_done
    s_sleep 1
    s_branch L_fpoll
L_fpoll_done:
    s_mov_b64 exec, -1
    s_mov_b32 s72, 0
Lw_32:
    ds_read_b32 v6, v8 offset:16
    s_add_u32 s72, s72, 1
    s_cmp_ge_u32 s72, 524288
    s_waitcnt lgkmcnt(0)
    v_cmp_gt_u32 vcc, 1, v6
    s_cbranch_vccz Lwd_33
    s_cbranch_scc1 Lwd_33
    s_branch Lw_32
Lwd_33:
    s_cmp_lt_u32 s45, 9
    s_cselect_b32 s46, 0, 110592
    s_lshl_b32 s41, s45, 12
    s_add_u32 s46, s46, s41
    s_mov_b32 m0, s47
    s_add_u32 s45, s45, 1
    buffer_load_dwordx4 v18, s[56:59], s46 offen offset:0 sc1 lds
    buffer_load_dwordx4 v18, s[56:59], s46 offen offset:1024 sc1 lds
    buffer_load_dwordx4 v18, s[56:59], s46 offen offset:2048 sc1 lds
    buffer_load_dwordx4 v18, s[56:59], s46 offen offset:3072 sc1 lds
    s_cmp_ge_u32 s45, 18
    s_cselect_b32 s45, 0, s45
    s_add_u32 s47, s47, 8192
    s_and_b32 s47, s47, 32767
    s_cmp_lt_u32 s45, 9
    s_cselect_b32 s46, 0, 110592
    s_lshl_b32 s41, s45, 12
    s_add_u32 s46, s46, s41
    s_mov_b32 m0, s47
    s_add_u32 s45, s45, 1
    buffer_load_dwordx4 v18, s[56:59], s46 offen offset:0 sc1 lds
    buffer_load_dwordx4 v18, s[56:59], s46 offen offset:1024 sc1 lds
    buffer_load_dwordx4 v18, s[56:59], s46 offen offset:2048 sc1 lds
    buffer_load_dwordx4 v18, s[56:59], s46 offen offset:3072 sc1 lds
    s_cmp_ge_u32 s45, 18
    s_cselect_b32 s45, 0, s45
    s_add_u32 s47, s47, 8192
    s_and_b32 s47, s47, 32767
    s_cmp_lt_u32 s45, 9
    s_cselect_b32 s46, 0, 110592
    s_lshl_b32 s41, s45, 12
    s_add_u32 s46, s46, s41
    s_mov_b32 m0, s47
    s_add_u32 s45, s45, 1
    buffer_load_dwordx4 v18, s[56:59], s46 offen offset:0 sc1 lds
    buffer_load_dwordx4 v18, s[56:59], s46 offen offset:1024 sc1 lds
    buffer_load_dwordx4 v18, s[56:59], s46 offen offset:2048 sc1 lds
    buffer_load_dwordx4 v18, s[56:59], s46 offen offset:3072 sc1 lds
    s_cmp_ge_u32 s45, 18
    s_cselect_b32 s45, 0, s45
    s_add_u32 s47, s47, 8192
    s_and_b32 s47, s47, 32767
    s_cmp_lt_u32 s45, 9
    s_cselect_b32 s46, 0, 110592
    s_lshl_b32 s41, s45, 12
    s_add_u32 s46, s46, s41
    s_mov_b32 m0, s47
    s_add_u32 s45, s45, 1
    buffer_load_dwordx4 v18, s[56:59], s46 offen offset:0 sc1 lds
    buffer_load_dwordx4 v18, s[56:59], s46 offen offset:1024 sc1 lds
    buffer_load_dwordx4 v18, s[56:59], s46 offen offset:2048 sc1 lds
    buffer_load_dwordx4 v18, s[56:59], s46 offen offset:3072 sc1 lds
    s_cmp_ge_u32 s45, 18
    s_cselect_b32 s45, 0, s45
    s_add_u32 s47, s47, 8192
    s_and_b32 s47, s47, 32767
    s_waitcnt vmcnt(12)
    s_barrier
    s_waitcnt vmcnt(8)
    s_mov_b32 s60, 1
L_h_loop:
    s_barrier
    s_cmp_lt_u32 s45, 9
    s_cselect_b32 s46, 0, 110592
    s_lshl_b32 s41, s45, 12
    s_add_u32 s46, s46, s41
    s_mov_b32 m0, s47
    s_add_u32 s45, s45, 1
    buffer_load_dwordx4 v18, s[56:59], s46 offen offset:0 sc1 lds
    buffer_load_dwordx4 v18, s[56:59], s46 offen offset:1024 sc1 lds
    buffer_load_dwordx4 v18, s[56:59], s46 offen offset:2048 sc1 lds
    buffer_load_dwordx4 v18, s[56:59], s46 offen offset:3072 sc1 lds
    s_cmp_ge_u32 s45, 18
    s_cselect_b32 s45, 0, s45
    s_add_u32 s47, s47, 8192
    s_and_b32 s47, s47, 32767
    s_waitcnt vmcnt(8)
    s_add_u32 s60, s60, 1
    s_cmp_lt_u32 s60, 15
    s_cbranch_scc1 L_h_loop
    s_barrier
    s_waitcnt vmcnt(4)
    s_barrier
    s_waitcnt vmcnt(0)
    s_barrier
    s_endpgm
L_compute:
    s_lshl_b32 s40, s3, 8
    s_add_u32 s40, s40, 154880
    v_lshlrev_b32 v1, 2, v0
    v_add_u32 v1, s40, v1
    v_mov_b32 v2, 0
    ds_write_b32 v1, v2
    s_waitcnt lgkmcnt(0)
    v_and_b32 v1, 15, v0
    v_lshrrev_b32 v2, 4, v0
    s_and_b32 s60, s3, 1
    s_lshr_b32 s61, s3, 1
    s_lshr_b32 s62, s6, 2
    s_and_b32 s63, s6, 3
    s_lshl_b32 s64, s5, 7
    s_lshl_b32 s65, s62, 6
    s_add_u32 s64, s64, s65
    s_lshl_b32 s65, s60, 5
    s_add_u32 s64, s64, s65
    s_mul_i32 s65, s63, 144
    s_mul_i32 s66, s61, 80
    s_add_u32 s65, s65, s66
    v_lshrrev_b32 v9, 1, v1
    v_xor_b32 v9, v9, v2
    v_lshlrev_b32 v9, 4, v9
    v_lshl_add_u32 v172, v1, 7, v9
    v_xor_b32 v173, 64, v172
    s_lshl_b32 s40, s3, 12
    v_add_u32 v174, s40, v172
    v_add_u32 v175, s40, v173
    v_mov_b32 v100, 0
    v_mov_b32 v101, 0
    v_mov_b32 v102, 0
    v_mov_b32 v103, 0
    v_mov_b32 v104, 0
    v_mov_b32 v105, 0
    v_mov_b32 v106, 0
    v_mov_b32 v107, 0
    v_mov_b32 v108, 0
    v_mov_b32 v109, 0
    v_mov_b32 v110, 0
    v_mov_b32 v111, 0
    v_mov_b32 v112, 0
    v_mov_b32 v113, 0
    v_mov_b32 v114, 0
    v_mov_b32 v115, 0
    v_mov_b32 v116, 0
    v_mov_b32 v117, 0
    v_mov_b32 v118, 0
    v_mov_b32 v119, 0
    v_mov_b32 v120, 0
    v_mov_b32 v121, 0
    v_mov_b32 v122, 0
    v_mov_b32 v123, 0
    v_mov_b32 v124, 0
    v_mov_b32 v125, 0
    v_mov_b32 v126, 0
    v_mov_b32 v127, 0
    v_mov_b32 v128, 0
    v_mov_b32 v129, 0
    v_mov_b32 v130, 0
    v_mov_b32 v131, 0
    v_mov_b32 v132, 0
    v_mov_b32 v133, 0
    v_mov_b32 v134, 0
    v_mov_b32 v135, 0
    v_mov_b32 v136, 0
    v_mov_b32 v137, 0
    v_mov_b32 v138, 0
    v_mov_b32 v139, 0
    v_mov_b32 v140, 0
    v_mov_b32 v141, 0
    v_mov_b32 v142, 0
    v_mov_b32 v143, 0
    v_mov_b32 v144, 0
    v_mov_b32 v145, 0
    v_mov_b32 v146, 0
    v_mov_b32 v147, 0
    v_mov_b32 v148, 0
    v_mov_b32 v149, 0
    v_mov_b32 v150, 0
    v_mov_b32 v151, 0
    v_mov_b32 v152, 0
    v_mov_b32 v153, 0
    v_mov_b32 v154, 0
    v_mov_b32 v155, 0
    v_mov_b32 v156, 0
    v_mov_b32 v157, 0
    v_mov_b32 v158, 0
    v_mov_b32 v159, 0
    v_mov_b32 v160, 0
    v_mov_b32 v161, 0
    v_mov_b32 v162, 0
    v_mov_b32 v163, 0
    v_mov_b32 v164, 0
    v_mov_b32 v165, 0
    v_mov_b32 v166, 0
    v_mov_b32 v167, 0
    v_mov_b32 v168, 0
    v_mov_b32 v169, 0
    v_mov_b32 v170, 0
    v_mov_b32 v171, 0
    s_lshl_b32 s41, s61, 6
    v_xor_b32 v9, s41, v172
    v_add_u32 v240, 40960, v9
    s_mul_i32 s41, s61, 10240
    s_add_u32 s41, s41, 32768
    v_add_u32 v239, s41, v9
    v_lshrrev_b32 v9, 2, v1
    v_and_b32 v10, 1, v2
    v_lshlrev_b32 v10, 2, v10
    v_xor_b32 v9, v9, v10
    v_lshlrev_b32 v9, 4, v9
    v_lshl_add_u32 v9, v2, 9, v9
    v_and_b32 v10, 1, v1
    v_lshl_add_u32 v9, v10, 3, v9
    v_and_b32 v10, 2, v1
    v_lshl_add_u32 v9, v10, 6, v9
    s_lshl_b32 s41, s60, 12
    s_lshl_b32 s42, s61, 11
    s_add_u32 s41, s41, s42
    v_add_u32 v238, s41, v9
    v_and_b32 v252, 3, v0
    v_lshlrev_b32 v252, 2, v252
    v_add_u32 v252, 155456, v252
    v_and_b32 v253, 1, v0
    v_lshlrev_b32 v253, 2, v253
    v_add_u32 v253, 155456, v253
    s_lshl_b32 s40, s3, 2
    s_add_u32 s41, s40, 155472
    v_mov_b32 v242, s41
    v_mov_b32 v243, 0
    v_add_u32 v4, s40, v2
    v_lshlrev_b32 v10, 3, v4
    v_cvt_f32_u32 v10, v10
    v_lshrrev_b32 v6, 3, v1
    v_and_b32 v8, 7, v1
    v_mul_u32_u24 v5, 576, v4
    v_add_u32 v5, 145664, v5
    v_lshlrev_b32 v9, 3, v8
    v_lshl_add_u32 v9, v6, 2, v9
    v_add_u32 v244, v5, v9
    v_add_u32 v245, 154880, v9
    v_lshl_add_u32 v5, v1, 3, v5
    v_lshlrev_b32 v9, 3, v1
    v_add_u32 v9, 154880, v9
    v_lshlrev_b32 v246, 31, v6
    v_lshlrev_b32 v11, 4, v8
    v_add_u32 v11, 144384, v11
    s_mul_i32 s40, s32, 294912
    s_mul_i32 s41, s3, 36864
    s_add_u32 s40, s40, s41
    s_mul_i32 s41, s6, 4608
    s_add_u32 s57, s40, s41
    s_add_u32 s56, s57, 4096
    s_add_u32 s55, s57, 147456
    s_and_b32 s41, s6, 1
    s_lshl_b32 s41, s41, 2
    v_xor_b32 v8, s41, v8
    v_lshlrev_b32 v7, 2, v6
    v_xor_b32 v7, v7, v8
    v_lshlrev_b32 v7, 4, v7
    v_lshl_add_u32 v7, v2, 7, v7
    v_lshl_add_u32 v7, v6, 9, v7
    s_mov_b32 s41, 147456
    v_mul_lo_u32 v6, v6, s41
    v_lshl_add_u32 v8, v8, 4, v6
    v_lshl_add_u32 v8, v2, 7, v8
    v_lshlrev_b32 v3, 4, v1
    v_add_u32 v3, 143360, v3
    s_mov_b32 s44, s30
    s_mov_b32 s45, s31
    s_mov_b32 s46, 9437184
    s_mov_b32 s47, 0x20000
    s_lshl_b32 s40, s32, 8
    s_add_u32 s40, s40, 11534336
    s_add_u32 s48, s30, s40
    s_addc_u32 s49, s31, 0
    s_mov_b32 s50, 256
    s_mov_b32 s51, 0x20000
    s_mov_b32 s58, 0
    s_mov_b32 s59, 0
    v_mov_b32 v179, v175
    v_mov_b32 v177, v173
    v_mov_b32 v243, 1
    s_barrier
    s_setprio 3
    ds_read_b128 v[12:15], v174 offset:0
    ds_read_b128 v[20:23], v172 offset:16384
    ds_read_b128 v[16:19], v174 offset:2048
    ds_read_b128 v[24:27], v172 offset:18432
    ds_read_b128 v[28:31], v172 offset:20480
    ds_read_b128 v[32:35], v172 offset:22528
    ds_read_b128 v[36:39], v172 offset:24576
    ds_read_b128 v[40:43], v172 offset:26624
    ds_read_b128 v[44:47], v172 offset:28672
    ds_read_b128 v[48:51], v172 offset:30720
    ds_read_b128 v[52:55], v172 offset:32768
.p2align 6
L_c1_loop:
    s_add_u32 s58, s58, 34816
    s_cmp_ge_u32 s58, 104448
    s_cselect_b32 s58, 0, s58
    s_waitcnt lgkmcnt(9)
    v_mfma_f32_16x16x32_bf16 v[100:103], v[12:15], v[20:23], v[100:103]
    ds_read_b128 v[56:59], v179 offset:0
    s_waitcnt lgkmcnt(9)
    v_mfma_f32_16x16x32_bf16 v[104:107], v[16:19], v[20:23], v[104:107]
    ds_read_b128 v[64:67], v177 offset:16384
    s_waitcnt lgkmcnt(9)
    v_mfma_f32_16x16x32_bf16 v[108:111], v[12:15], v[24:27], v[108:111]
    ds_read_b128 v[60:63], v179 offset:2048
    v_mfma_f32_16x16x32_bf16 v[112:115], v[16:19], v[24:27], v[112:115]
    ds_read_b128 v[68:71], v177 offset:18432
    s_waitcnt lgkmcnt(10)
    v_mfma_f32_16x16x32_bf16 v[116:119], v[12:15], v[28:31], v[116:119]
    ds_read_b128 v[72:75], v177 offset:20480
    v_mfma_f32_16x16x32_bf16 v[120:123], v[16:19], v[28:31], v[120:123]
    ds_read_b128 v[76:79], v177 offset:22528
    s_waitcnt lgkmcnt(11)
    v_mfma_f32_16x16x32_bf16 v[124:127], v[12:15], v[32:35], v[124:127]
    ds_read_b128 v[80:83], v177 offset:24576
    v_mfma_f32_16x16x32_bf16 v[128:131], v[16:19], v[32:35], v[128:131]
    ds_read_b128 v[84:87], v177 offset:26624
    s_waitcnt lgkmcnt(12)
    v_mfma_f32_16x16x32_bf16 v[132:135], v[12:15], v[36:39], v[132:135]
    ds_read_b128 v[88:91], v177 offset:28672
    v_mfma_f32_16x16x32_bf16 v[136:139], v[16:19], v[36:39], v[136:139]
    ds_read_b128 v[92:95], v177 offset:30720
    s_waitcnt lgkmcnt(13)
    v_mfma_f32_16x16x32_bf16 v[140:143], v[12:15], v[40:43], v[140:143]
    ds_read_b128 v[96:99], v177 offset:32768
    v_mfma_f32_16x16x32_bf16 v[144:147], v[16:19], v[40:43], v[144:147]
    v_add_u32 v178, s58, v174
    s_waitcnt lgkmcnt(13)
    v_mfma_f32_16x16x32_bf16 v[148:151], v[12:15], v[44:47], v[148:151]
    v_add_u32 v176, s58, v172
    v_mfma_f32_16x16x32_bf16 v[152:155], v[16:19], v[44:47], v[152:155]
    v_add_u32 v179, s58, v175
    s_waitcnt lgkmcnt(12)
    v_mfma_f32_16x16x32_bf16 v[156:159], v[12:15], v[48:51], v[156:159]
    v_add_u32 v177, s58, v173
    v_mfma_f32_16x16x32_bf16 v[160:163], v[16:19], v[48:51], v[160:163]
    s_add_u32 s59, s59, 1
    s_waitcnt lgkmcnt(11)
    v_mfma_f32_16x16x32_bf16 v[164:167], v[12:15], v[52:55], v[164:167]
    s_cmp_lt_u32 s59, 9
    v_mfma_f32_16x16x32_bf16 v[168:171], v[16:19], v[52:55], v[168:171]
    s_cbranch_scc0 L_c1_tail
    s_waitcnt lgkmcnt(9)
    v_mfma_f32_16x16x32_bf16 v[100:103], v[56:59], v[64:67], v[100:103]
    s_waitcnt lgkmcnt(8)
    v_mfma_f32_16x16x32_bf16 v[104:107], v[60:63], v[64:67], v[104:107]
    s_waitcnt lgkmcnt(7)
    v_mfma_f32_16x16x32_bf16 v[108:111], v[56:59], v[68:71], v[108:111]
    v_mfma_f32_16x16x32_bf16 v[112:115], v[60:63], v[68:71], v[112:115]
    s_waitcnt lgkmcnt(6)
    v_mfma_f32_16x16x32_bf16 v[116:119], v[56:59], v[72:75], v[116:119]
    v_mfma_f32_16x16x32_bf16 v[120:123], v[60:63], v[72:75], v[120:123]
    s_waitcnt lgkmcnt(0)
    s_barrier
    v_mfma_f32_16x16x32_bf16 v[124:127], v[56:59], v[76:79], v[124:127]
    ds_read_b128 v[12:15], v178 offset:0
    v_mfma_f32_16x16x32_bf16 v[128:131], v[60:63], v[76:79], v[128:131]
    ds_read_b128 v[20:23], v176 offset:16384
    v_mfma_f32_16x16x32_bf16 v[132:135], v[56:59], v[80:83], v[132:135]
    ds_read_b128 v[16:19], v178 offset:2048
    v_mfma_f32_16x16x32_bf16 v[136:139], v[60:63], v[80:83], v[136:139]
    ds_read_b128 v[24:27], v176 offset:18432
    v_mfma_f32_16x16x32_bf16 v[140:143], v[56:59], v[84:87], v[140:143]
    ds_read_b128 v[28:31], v176 offset:20480
    v_mfma_f32_16x16x32_bf16 v[144:147], v[60:63], v[84:87], v[144:147]
    ds_read_b128 v[32:35], v176 offset:22528
    v_mfma_f32_16x16x32_bf16 v[148:151], v[56:59], v[88:91], v[148:151]
    ds_read_b128 v[36:39], v176 offset:24576
    v_mfma_f32_16x16x32_bf16 v[152:155], v[60:63], v[88:91], v[152:155]
    ds_read_b128 v[40:43], v176 offset:26624
    v_mfma_f32_16x16x32_bf16 v[156:159], v[56:59], v[92:95], v[156:159]
    ds_read_b128 v[44:47], v176 offset:28672
    v_mfma_f32_16x16x32_bf16 v[160:163], v[60:63], v[92:95], v[160:163]
    ds_read_b128 v[48:51], v176 offset:30720
    v_mfma_f32_16x16x32_bf16 v[164:167], v[56:59], v[96:99], v[164:167]
    ds_read_b128 v[52:55], v176 offset:32768
    v_mfma_f32_16x16x32_bf16 v[168:171], v[60:63], v[96:99], v[168:171]
    s_branch L_c1_loop
L_c1_tail:
    s_waitcnt lgkmcnt(9)
    v_mfma_f32_16x16x32_bf16 v[100:103], v[56:59], v[64:67], v[100:103]
    ds_read_b128 v[12:15], v3 offset:0
    s_waitcnt lgkmcnt(9)
    v_mfma_f32_16x16x32_bf16 v[104:107], v[60:63], v[64:67], v[104:107]
    ds_read_b128 v[16:19], v3 offset:256
    s_waitcnt lgkmcnt(9)
    v_mfma_f32_16x16x32_bf16 v[108:111], v[56:59], v[68:71], v[108:111]
    ds_read_b128 v[20:23], v3 offset:512
    v_mfma_f32_16x16x32_bf16 v[112:115], v[60:63], v[68:71], v[112:115]
    ds_read_b128 v[24:27], v3 offset:768
    s_waitcnt lgkmcnt(10)
    v_mfma_f32_16x16x32_bf16 v[116:119], v[56:59], v[72:75], v[116:119]
    ds_read_b128 v[28:31], v11
    v_mfma_f32_16x16x32_bf16 v[120:123], v[60:63], v[72:75], v[120:123]
    ds_read_b128 v[32:35], v3 offset:1152
    s_waitcnt lgkmcnt(11)
    v_mfma_f32_16x16x32_bf16 v[124:127], v[56:59], v[76:79], v[124:127]
    ds_read_b128 v[36:39], v3 offset:1408
    v_mfma_f32_16x16x32_bf16 v[128:131], v[60:63], v[76:79], v[128:131]
    ds_read_b128 v[40:43], v3 offset:1664
    s_waitcnt lgkmcnt(12)
    v_mfma_f32_16x16x32_bf16 v[132:135], v[56:59], v[80:83], v[132:135]
    ds_read_b128 v[44:47], v3 offset:1920
    v_mfma_f32_16x16x32_bf16 v[136:139], v[60:63], v[80:83], v[136:139]
    ds_read_b128 v[48:51], v11 offset:1152
    s_waitcnt lgkmcnt(13)
    v_mfma_f32_16x16x32_bf16 v[140:143], v[56:59], v[84:87], v[140:143]
    s_nop 0
    v_mfma_f32_16x16x32_bf16 v[144:147], v[60:63], v[84:87], v[144:147]
    s_nop 0
    s_waitcnt lgkmcnt(12)
    v_mfma_f32_16x16x32_bf16 v[148:151], v[56:59], v[88:91], v[148:151]
    s_nop 0
    v_mfma_f32_16x16x32_bf16 v[152:155], v[60:63], v[88:91], v[152:155]
    s_waitcnt lgkmcnt(0)
    v_mfma_f32_16x16x32_bf16 v[156:159], v[56:59], v[92:95], v[156:159]
    v_xor_b32 v52, v246, v29
    v_mfma_f32_16x16x32_bf16 v[160:163], v[60:63], v[92:95], v[160:163]
    v_xor_b32 v53, v246, v30
    v_mfma_f32_16x16x32_bf16 v[164:167], v[56:59], v[96:99], v[164:167]
    v_xor_b32 v55, v246, v49
    v_mfma_f32_16x16x32_bf16 v[168:171], v[60:63], v[96:99], v[168:171]
    s_waitcnt lgkmcnt(0)
    s_nop 3
    v_pk_fma_f32 v[56:57], v[12:13], v[100:101], v[102:103] op_sel:[0,0,0] op_sel_hi:[0,1,1]
    v_pk_fma_f32 v[58:59], v[12:13], v[108:109], v[110:111] op_sel:[0,0,0] op_sel_hi:[0,1,1]
    v_pk_fma_f32 v[60:61], v[16:17], v[116:117], v[118:119] op_sel:[0,0,0] op_sel_hi:[0,1,1]
    v_pk_fma_f32 v[62:63], v[16:17], v[124:125], v[126:127] op_sel:[0,0,0] op_sel_hi:[0,1,1]
    v_pk_fma_f32 v[64:65], v[20:21], v[132:133], v[134:135] op_sel:[0,0,0] op_sel_hi:[0,1,1]
    v_pk_fma_f32 v[66:67], v[20:21], v[140:141], v[142:143] op_sel:[0,0,0] op_sel_hi:[0,1,1]
    v_pk_fma_f32 v[68:69], v[24:25], v[148:149], v[150:151] op_sel:[0,0,0] op_sel_hi:[0,1,1]
    v_pk_fma_f32 v[70:71], v[24:25], v[156:157], v[158:159] op_sel:[0,0,0] op_sel_hi:[0,1,1]
    v_fma_f32 v96, v28, v164, v166
    v_pk_fma_f32 v[56:57], v[12:13], v[108:109], v[56:57] op_sel:[1,0,0] op_sel_hi:[1,1,1] neg_lo:[1,0,0] neg_hi:[1,0,0]
    v_pk_fma_f32 v[58:59], v[12:13], v[100:101], v[58:59] op_sel:[1,0,0] op_sel_hi:[1,1,1]
    v_pk_fma_f32 v[60:61], v[16:17], v[124:125], v[60:61] op_sel:[1,0,0] op_sel_hi:[1,1,1] neg_lo:[1,0,0] neg_hi:[1,0,0]
    v_fmac_f32_dpp v96, -v164, v52 row_ror:8 row_mask:0xf bank_mask:0xf
    v_pk_fma_f32 v[62:63], v[16:17], v[116:117], v[62:63] op_sel:[1,0,0] op_sel_hi:[1,1,1]
    v_pk_fma_f32 v[64:65], v[20:21], v[140:141], v[64:65] op_sel:[1,0,0] op_sel_hi:[1,1,1] neg_lo:[1,0,0] neg_hi:[1,0,0]
    v_pk_fma_f32 v[66:67], v[20:21], v[132:133], v[66:67] op_sel:[1,0,0] op_sel_hi:[1,1,1]
    v_fma_f32 v97, v28, v96, v168
    v_pk_fma_f32 v[68:69], v[24:25], v[156:157], v[68:69] op_sel:[1,0,0] op_sel_hi:[1,1,1] neg_lo:[1,0,0] neg_hi:[1,0,0]
    v_pk_fma_f32 v[70:71], v[24:25], v[148:149], v[70:71] op_sel:[1,0,0] op_sel_hi:[1,1,1]
    v_pk_fma_f32 v[72:73], v[12:13], v[56:57], v[104:105] op_sel:[0,0,0] op_sel_hi:[0,1,1]
    v_fmac_f32_dpp v97, -v96, v52 row_ror:8 row_mask:0xf bank_mask:0xf
    v_pk_fma_f32 v[74:75], v[12:13], v[58:59], v[112:113] op_sel:[0,0,0] op_sel_hi:[0,1,1]
    v_pk_fma_f32 v[76:77], v[16:17], v[60:61], v[120:121] op_sel:[0,0,0] op_sel_hi:[0,1,1]
    v_pk_fma_f32 v[78:79], v[16:17], v[62:63], v[128:129] op_sel:[0,0,0] op_sel_hi:[0,1,1]
    v_fma_f32 v96, v28, v97, v170
    v_pk_fma_f32 v[80:81], v[20:21], v[64:65], v[136:137] op_sel:[0,0,0] op_sel_hi:[0,1,1]
    v_pk_fma_f32 v[82:83], v[20:21], v[66:67], v[144:145] op_sel:[0,0,0] op_sel_hi:[0,1,1]
    v_pk_fma_f32 v[84:85], v[24:25], v[68:69], v[152:153] op_sel:[0,0,0] op_sel_hi:[0,1,1]
    v_fmac_f32_dpp v96, -v97, v52 row_ror:8 row_mask:0xf bank_mask:0xf
    v_pk_fma_f32 v[86:87], v[24:25], v[70:71], v[160:161] op_sel:[0,0,0] op_sel_hi:[0,1,1]
    v_pk_fma_f32 v[72:73], v[12:13], v[58:59], v[72:73] op_sel:[1,0,0] op_sel_hi:[1,1,1] neg_lo:[1,0,0] neg_hi:[1,0,0]
    v_pk_fma_f32 v[74:75], v[12:13], v[56:57], v[74:75] op_sel:[1,0,0] op_sel_hi:[1,1,1]
    v_fma_f32 v97, v28, v96, v165
    v_pk_fma_f32 v[76:77], v[16:17], v[62:63], v[76:77] op_sel:[1,0,0] op_sel_hi:[1,1,1] neg_lo:[1,0,0] neg_hi:[1,0,0]
    v_pk_fma_f32 v[78:79], v[16:17], v[60:61], v[78:79] op_sel:[1,0,0] op_sel_hi:[1,1,1]
    v_pk_fma_f32 v[80:81], v[20:21], v[66:67], v[80:81] op_sel:[1,0,0] op_sel_hi:[1,1,1] neg_lo:[1,0,0] neg_hi:[1,0,0]
    v_fmac_f32_dpp v97, -v96, v52 row_ror:8 row_mask:0xf bank_mask:0xf
    v_pk_fma_f32 v[82:83], v[20:21], v[64:65], v[82:83] op_sel:[1,0,0] op_sel_hi:[1,1,1]
    v_pk_fma_f32 v[84:85], v[24:25], v[70:71], v[84:85] op_sel:[1,0,0] op_sel_hi:[1,1,1] neg_lo:[1,0,0] neg_hi:[1,0,0]
    v_pk_fma_f32 v[86:87], v[24:25], v[68:69], v[86:87] op_sel:[1,0,0] op_sel_hi:[1,1,1]
    v_fma_f32 v96, v28, v97, v167
    v_pk_fma_f32 v[56:57], v[12:13], v[72:73], v[106:107] op_sel:[0,0,0] op_sel_hi:[0,1,1]
    v_pk_fma_f32 v[58:59], v[12:13], v[74:75], v[114:115] op_sel:[0,0,0] op_sel_hi:[0,1,1]
    v_pk_fma_f32 v[60:61], v[16:17], v[76:77], v[122:123] op_sel:[0,0,0] op_sel_hi:[0,1,1]
    v_fmac_f32_dpp v96, -v97, v52 row_ror:8 row_mask:0xf bank_mask:0xf
    v_pk_fma_f32 v[62:63], v[16:17], v[78:79], v[130:131] op_sel:[0,0,0] op_sel_hi:[0,1,1]
    v_pk_fma_f32 v[64:65], v[20:21], v[80:81], v[138:139] op_sel:[0,0,0] op_sel_hi:[0,1,1]
    v_pk_fma_f32 v[66:67], v[20:21], v[82:83], v[146:147] op_sel:[0,0,0] op_sel_hi:[0,1,1]
    v_fma_f32 v97, v28, v96, v169
    v_pk_fma_f32 v[68:69], v[24:25], v[84:85], v[154:155] op_sel:[0,0,0] op_sel_hi:[0,1,1]
    v_pk_fma_f32 v[70:71], v[24:25], v[86:87], v[162:163] op_sel:[0,0,0] op_sel_hi:[0,1,1]
    v_pk_fma_f32 v[56:57], v[12:13], v[74:75], v[56:57] op_sel:[1,0,0] op_sel_hi:[1,1,1] neg_lo:[1,0,0] neg_hi:[1,0,0]
    v_fmac_f32_dpp v97, -v96, v52 row_ror:8 row_mask:0xf bank_mask:0xf
    v_pk_fma_f32 v[58:59], v[12:13], v[72:73], v[58:59] op_sel:[1,0,0] op_sel_hi:[1,1,1]
    v_pk_fma_f32 v[60:61], v[16:17], v[78:79], v[60:61] op_sel:[1,0,0] op_sel_hi:[1,1,1] neg_lo:[1,0,0] neg_hi:[1,0,0]
    v_pk_fma_f32 v[62:63], v[16:17], v[76:77], v[62:63] op_sel:[1,0,0] op_sel_hi:[1,1,1]
    v_fma_f32 v96, v28, v97, v171
    v_pk_fma_f32 v[64:65], v[20:21], v[82:83], v[64:65] op_sel:[1,0,0] op_sel_hi:[1,1,1] neg_lo:[1,0,0] neg_hi:[1,0,0]
    v_pk_fma_f32 v[66:67], v[20:21], v[80:81], v[66:67] op_sel:[1,0,0] op_sel_hi:[1,1,1]
    v_pk_fma_f32 v[68:69], v[24:25], v[86:87], v[68:69] op_sel:[1,0,0] op_sel_hi:[1,1,1] neg_lo:[1,0,0] neg_hi:[1,0,0]
    v_fmac_f32_dpp v96, -v97, v52 row_ror:8 row_mask:0xf bank_mask:0xf
    v_pk_fma_f32 v[70:71], v[24:25], v[84:85], v[70:71] op_sel:[1,0,0] op_sel_hi:[1,1,1]
    v_fma_f32 v88, v34, v56, v57
    v_fma_f32 v89, v34, v58, v59
    v_fma_f32 v90, v38, v60, v61
    v_fma_f32 v91, v38, v62, v63
    v_fma_f32 v92, v42, v64, v65
    v_fma_f32 v93, v42, v66, v67
    v_fma_f32 v94, v46, v68, v69
    v_fma_f32 v95, v46, v70, v71
    v_fma_f32 v88, -v35, v58, v88
    v_fmac_f32 v89, v35, v56
    ds_write_b64 v5, v[88:89] offset:0
    v_fma_f32 v90, -v39, v62, v90
    v_fmac_f32 v91, v39, v60
    ds_write_b64 v5, v[90:91] offset:128
    v_fma_f32 v92, -v43, v66, v92
    v_fmac_f32 v93, v43, v64
    ds_write_b64 v5, v[92:93] offset:256
    v_fma_f32 v94, -v47, v70, v94
    v_fmac_f32 v95, v47, v68
    ds_write_b64 v5, v[94:95] offset:384
    ds_write_b32 v244, v96 offset:512
    s_mov_b64 exec, 1
    ds_write_b32 v242, v243 offset:32
    s_mov_b64 exec, -1
    s_setprio 0
    v_pk_mul_f32 v[180:181], v[14:15], v[108:109] op_sel:[1,0] op_sel_hi:[1,1] neg_lo:[1,0] neg_hi:[1,0]
    v_pk_mul_f32 v[182:183], v[18:19], v[124:125] op_sel:[1,0] op_sel_hi:[1,1] neg_lo:[1,0] neg_hi:[1,0]
    v_pk_mul_f32 v[184:185], v[22:23], v[140:141] op_sel:[1,0] op_sel_hi:[1,1] neg_lo:[1,0] neg_hi:[1,0]
    v_pk_mul_f32 v[186:187], v[26:27], v[156:157] op_sel:[1,0] op_sel_hi:[1,1] neg_lo:[1,0] neg_hi:[1,0]
    v_pk_mul_f32 v[108:109], v[14:15], v[108:109] op_sel:[0,0] op_sel_hi:[0,1] neg_lo:[1,0] neg_hi:[1,0]
    v_pk_mul_f32 v[124:125], v[18:19], v[124:125] op_sel:[0,0] op_sel_hi:[0,1] neg_lo:[1,0] neg_hi:[1,0]
    v_pk_mul_f32 v[140:141], v[22:23], v[140:141] op_sel:[0,0] op_sel_hi:[0,1] neg_lo:[1,0] neg_hi:[1,0]
    v_pk_mul_f32 v[156:157], v[26:27], v[156:157] op_sel:[0,0] op_sel_hi:[0,1] neg_lo:[1,0] neg_hi:[1,0]
    v_pk_fma_f32 v[108:109], v[14:15], v[100:101], v[108:109] op_sel:[1,0,0] op_sel_hi:[1,1,1] neg_lo:[1,0,0] neg_hi:[1,0,0]
    v_pk_fma_f32 v[124:125], v[18:19], v[116:117], v[124:125] op_sel:[1,0,0] op_sel_hi:[1,1,1] neg_lo:[1,0,0] neg_hi:[1,0,0]
    v_pk_fma_f32 v[140:141], v[22:23], v[132:133], v[140:141] op_sel:[1,0,0] op_sel_hi:[1,1,1] neg_lo:[1,0,0] neg_hi:[1,0,0]
    v_pk_fma_f32 v[156:157], v[26:27], v[148:149], v[156:157] op_sel:[1,0,0] op_sel_hi:[1,1,1] neg_lo:[1,0,0] neg_hi:[1,0,0]
    v_pk_fma_f32 v[100:101], v[14:15], v[100:101], v[180:181] op_sel:[0,0,0] op_sel_hi:[0,1,1]
    v_pk_fma_f32 v[116:117], v[18:19], v[116:117], v[182:183] op_sel:[0,0,0] op_sel_hi:[0,1,1]
    v_pk_fma_f32 v[132:133], v[22:23], v[132:133], v[184:185] op_sel:[0,0,0] op_sel_hi:[0,1,1]
    v_pk_fma_f32 v[148:149], v[26:27], v[148:149], v[186:187] op_sel:[0,0,0] op_sel_hi:[0,1,1]
    v_pk_mul_f32 v[180:181], v[14:15], v[110:111] op_sel:[1,0] op_sel_hi:[1,1] neg_lo:[1,0] neg_hi:[1,0]
    v_pk_mul_f32 v[182:183], v[18:19], v[126:127] op_sel:[1,0] op_sel_hi:[1,1] neg_lo:[1,0] neg_hi:[1,0]
    v_pk_mul_f32 v[184:185], v[22:23], v[142:143] op_sel:[1,0] op_sel_hi:[1,1] neg_lo:[1,0] neg_hi:[1,0]
    v_pk_mul_f32 v[186:187], v[26:27], v[158:159] op_sel:[1,0] op_sel_hi:[1,1] neg_lo:[1,0] neg_hi:[1,0]
    v_pk_mul_f32 v[110:111], v[14:15], v[110:111] op_sel:[0,0] op_sel_hi:[0,1] neg_lo:[1,0] neg_hi:[1,0]
    v_pk_mul_f32 v[126:127], v[18:19], v[126:127] op_sel:[0,0] op_sel_hi:[0,1] neg_lo:[1,0] neg_hi:[1,0]
    v_pk_mul_f32 v[142:143], v[22:23], v[142:143] op_sel:[0,0] op_sel_hi:[0,1] neg_lo:[1,0] neg_hi:[1,0]
    v_pk_mul_f32 v[158:159], v[26:27], v[158:159] op_sel:[0,0] op_sel_hi:[0,1] neg_lo:[1,0] neg_hi:[1,0]
    v_pk_fma_f32 v[110:111], v[14:15], v[102:103], v[110:111] op_sel:[1,0,0] op_sel_hi:[1,1,1] neg_lo:[1,0,0] neg_hi:[1,0,0]
    v_pk_fma_f32 v[126:127], v[18:19], v[118:119], v[126:127] op_sel:[1,0,0] op_sel_hi:[1,1,1] neg_lo:[1,0,0] neg_hi:[1,0,0]
    v_pk_fma_f32 v[142:143], v[22:23], v[134:135], v[142:143] op_sel:[1,0,0] op_sel_hi:[1,1,1] neg_lo:[1,0,0] neg_hi:[1,0,0]
    v_pk_fma_f32 v[158:159], v[26:27], v[150:151], v[158:159] op_sel:[1,0,0] op_sel_hi:[1,1,1] neg_lo:[1,0,0] neg_hi:[1,0,0]
    v_pk_fma_f32 v[102:103], v[14:15], v[102:103], v[180:181] op_sel:[0,0,0] op_sel_hi:[0,1,1]
    v_pk_fma_f32 v[118:119], v[18:19], v[118:119], v[182:183] op_sel:[0,0,0] op_sel_hi:[0,1,1]
    v_pk_fma_f32 v[134:135], v[22:23], v[134:135], v[184:185] op_sel:[0,0,0] op_sel_hi:[0,1,1]
    v_pk_fma_f32 v[150:151], v[26:27], v[150:151], v[186:187] op_sel:[0,0,0] op_sel_hi:[0,1,1]
    v_pk_mul_f32 v[180:181], v[14:15], v[112:113] op_sel:[1,0] op_sel_hi:[1,1] neg_lo:[1,0] neg_hi:[1,0]
    v_pk_mul_f32 v[182:183], v[18:19], v[128:129] op_sel:[1,0] op_sel_hi:[1,1] neg_lo:[1,0] neg_hi:[1,0]
    v_pk_mul_f32 v[184:185], v[22:23], v[144:145] op_sel:[1,0] op_sel_hi:[1,1] neg_lo:[1,0] neg_hi:[1,0]
    v_pk_mul_f32 v[186:187], v[26:27], v[160:161] op_sel:[1,0] op_sel_hi:[1,1] neg_lo:[1,0] neg_hi:[1,0]
    v_pk_mul_f32 v[112:113], v[14:15], v[112:113] op_sel:[0,0] op_sel_hi:[0,1] neg_lo:[1,0] neg_hi:[1,0]
    v_pk_mul_f32 v[128:129], v[18:19], v[128:129] op_sel:[0,0] op_sel_hi:[0,1] neg_lo:[1,0] neg_hi:[1,0]
    v_pk_mul_f32 v[144:145], v[22:23], v[144:145] op_sel:[0,0] op_sel_hi:[0,1] neg_lo:[1,0] neg_hi:[1,0]
    v_pk_mul_f32 v[160:161], v[26:27], v[160:161] op_sel:[0,0] op_sel_hi:[0,1] neg_lo:[1,0] neg_hi:[1,0]
    v_pk_fma_f32 v[112:113], v[14:15], v[104:105], v[112:113] op_sel:[1,0,0] op_sel_hi:[1,1,1] neg_lo:[1,0,0] neg_hi:[1,0,0]
    v_pk_fma_f32 v[128:129], v[18:19], v[120:121], v[128:129] op_sel:[1,0,0] op_sel_hi:[1,1,1] neg_lo:[1,0,0] neg_hi:[1,0,0]
    v_pk_fma_f32 v[144:145], v[22:23], v[136:137], v[144:145] op_sel:[1,0,0] op_sel_hi:[1,1,1] neg_lo:[1,0,0] neg_hi:[1,0,0]
    v_pk_fma_f32 v[160:161], v[26:27], v[152:153], v[160:161] op_sel:[1,0,0] op_sel_hi:[1,1,1] neg_lo:[1,0,0] neg_hi:[1,0,0]
    v_pk_fma_f32 v[104:105], v[14:15], v[104:105], v[180:181] op_sel:[0,0,0] op_sel_hi:[0,1,1]
    v_pk_fma_f32 v[120:121], v[18:19], v[120:121], v[182:183] op_sel:[0,0,0] op_sel_hi:[0,1,1]
    v_pk_fma_f32 v[136:137], v[22:23], v[136:137], v[184:185] op_sel:[0,0,0] op_sel_hi:[0,1,1]
    v_pk_fma_f32 v[152:153], v[26:27], v[152:153], v[186:187] op_sel:[0,0,0] op_sel_hi:[0,1,1]
    v_pk_mul_f32 v[180:181], v[14:15], v[114:115] op_sel:[1,0] op_sel_hi:[1,1] neg_lo:[1,0] neg_hi:[1,0]
    v_pk_mul_f32 v[182:183], v[18:19], v[130:131] op_sel:[1,0] op_sel_hi:[1,1] neg_lo:[1,0] neg_hi:[1,0]
    v_pk_mul_f32 v[184:185], v[22:23], v[146:147] op_sel:[1,0] op_sel_hi:[1,1] neg_lo:[1,0] neg_hi:[1,0]
    v_pk_mul_f32 v[186:187], v[26:27], v[162:163] op_sel:[1,0] op_sel_hi:[1,1] neg_lo:[1,0] neg_hi:[1,0]
    v_pk_mul_f32 v[114:115], v[14:15], v[114:115] op_sel:[0,0] op_sel_hi:[0,1] neg_lo:[1,0] neg_hi:[1,0]
    v_pk_mul_f32 v[130:131], v[18:19], v[130:131] op_sel:[0,0] op_sel_hi:[0,1] neg_lo:[1,0] neg_hi:[1,0]
    v_pk_mul_f32 v[146:147], v[22:23], v[146:147] op_sel:[0,0] op_sel_hi:[0,1] neg_lo:[1,0] neg_hi:[1,0]
    v_pk_mul_f32 v[162:163], v[26:27], v[162:163] op_sel:[0,0] op_sel_hi:[0,1] neg_lo:[1,0] neg_hi:[1,0]
    v_pk_fma_f32 v[114:115], v[14:15], v[106:107], v[114:115] op_sel:[1,0,0] op_sel_hi:[1,1,1] neg_lo:[1,0,0] neg_hi:[1,0,0]
    v_pk_fma_f32 v[130:131], v[18:19], v[122:123], v[130:131] op_sel:[1,0,0] op_sel_hi:[1,1,1] neg_lo:[1,0,0] neg_hi:[1,0,0]
    v_pk_fma_f32 v[146:147], v[22:23], v[138:139], v[146:147] op_sel:[1,0,0] op_sel_hi:[1,1,1] neg_lo:[1,0,0] neg_hi:[1,0,0]
    v_pk_fma_f32 v[162:163], v[26:27], v[154:155], v[162:163] op_sel:[1,0,0] op_sel_hi:[1,1,1] neg_lo:[1,0,0] neg_hi:[1,0,0]
    v_pk_fma_f32 v[106:107], v[14:15], v[106:107], v[180:181] op_sel:[0,0,0] op_sel_hi:[0,1,1]
    v_pk_fma_f32 v[122:123], v[18:19], v[122:123], v[182:183] op_sel:[0,0,0] op_sel_hi:[0,1,1]
    v_pk_fma_f32 v[138:139], v[22:23], v[138:139], v[184:185] op_sel:[0,0,0] op_sel_hi:[0,1,1]
    v_pk_fma_f32 v[154:155], v[26:27], v[154:155], v[186:187] op_sel:[0,0,0] op_sel_hi:[0,1,1]
    v_mul_f32_dpp v188, -v164, v31 row_ror:8 row_mask:0xf bank_mask:0xf
    v_mul_f32_dpp v189, -v165, v31 row_ror:8 row_mask:0xf bank_mask:0xf
    v_mul_f32_dpp v190, -v166, v31 row_ror:8 row_mask:0xf bank_mask:0xf
    v_mul_f32_dpp v191, -v167, v31 row_ror:8 row_mask:0xf bank_mask:0xf
    v_mul_f32_dpp v192, -v168, v31 row_ror:8 row_mask:0xf bank_mask:0xf
    v_mul_f32_dpp v193, -v169, v31 row_ror:8 row_mask:0xf bank_mask:0xf
    v_mul_f32_dpp v194, -v170, v31 row_ror:8 row_mask:0xf bank_mask:0xf
    v_mul_f32_dpp v195, -v171, v31 row_ror:8 row_mask:0xf bank_mask:0xf
    v_fma_f32 v164, v53, v164, v188
    v_fma_f32 v165, v53, v165, v189
    v_fma_f32 v166, v53, v166, v190
    v_fma_f32 v167, v53, v167, v191
    v_fma_f32 v168, v53, v168, v192
    v_fma_f32 v169, v53, v169, v193
    v_fma_f32 v170, v53, v170, v194
    v_fma_f32 v171, v53, v171, v195
    v_mul_f32 v73, v14, v56
    v_mul_f32 v75, -v14, v58
    v_mul_f32 v77, v18, v60
    v_mul_f32 v79, -v18, v62
    v_mul_f32 v81, v22, v64
    v_mul_f32 v83, -v22, v66
    v_mul_f32 v85, v26, v68
    v_mul_f32 v87, -v26, v70
    v_fma_f32 v73, -v15, v58, v73
    v_fma_f32 v75, -v15, v56, v75
    v_fma_f32 v77, -v19, v62, v77
    v_fma_f32 v79, -v19, v60, v79
    v_fma_f32 v81, -v23, v66, v81
    v_fma_f32 v83, -v23, v64, v83
    v_fma_f32 v85, -v27, v70, v85
    v_fma_f32 v87, -v27, v68, v87
    v_add_f32 v247, 4.0, v10
    v_mul_f32 v196, v10, v32
    v_mul_f32 v222, v10, v33
    v_min_f32 v196, 0x42fc0000, v196
    v_mul_f32 v197, v247, v32
    v_mul_f32 v223, v247, v33
    v_min_f32 v197, 0x42fc0000, v197
    v_mul_f32 v198, v10, v36
    v_mul_f32 v226, v10, v37
    v_min_f32 v198, 0x42fc0000, v198
    v_mul_f32 v199, v247, v36
    v_mul_f32 v227, v247, v37
    v_min_f32 v199, 0x42fc0000, v199
    v_mul_f32 v200, v10, v40
    v_mul_f32 v230, v10, v41
    v_min_f32 v200, 0x42fc0000, v200
    v_mul_f32 v201, v247, v40
    v_mul_f32 v231, v247, v41
    v_min_f32 v201, 0x42fc0000, v201
    v_mul_f32 v202, v10, v44
    v_mul_f32 v234, v10, v45
    v_min_f32 v202, 0x42fc0000, v202
    v_mul_f32 v203, v247, v44
    v_mul_f32 v235, v247, v45
    v_min_f32 v203, 0x42fc0000, v203
    v_mul_f32 v204, v10, v48
    v_mul_f32 v237, v10, v55
    v_min_f32 v204, 0x42fc0000, v204
    v_exp_f32 v196, v196
    v_fract_f32 v222, v222
    v_exp_f32 v197, v197
    v_fract_f32 v223, v223
    v_exp_f32 v198, v198
    v_fract_f32 v226, v226
    v_exp_f32 v199, v199
    v_fract_f32 v227, v227
    v_exp_f32 v200, v200
    v_fract_f32 v230, v230
    v_exp_f32 v201, v201
    v_fract_f32 v231, v231
    v_exp_f32 v202, v202
    v_fract_f32 v234, v234
    v_exp_f32 v203, v203
    v_fract_f32 v235, v235
    v_exp_f32 v204, v204
    v_fract_f32 v237, v237
    v_cos_f32 v220, v222
    v_sin_f32 v222, v222
    v_cos_f32 v221, v223
    v_sin_f32 v223, v223
    v_cos_f32 v224, v226
    v_sin_f32 v226, v226
    v_cos_f32 v225, v227
    v_sin_f32 v227, v227
    v_cos_f32 v228, v230
    v_sin_f32 v230, v230
    v_cos_f32 v229, v231
    v_sin_f32 v231, v231
    v_cos_f32 v232, v234
    v_sin_f32 v234, v234
    v_cos_f32 v233, v235
    v_sin_f32 v235, v235
    v_cos_f32 v236, v237
    v_sin_f32 v237, v237
    v_mul_f32 v220, v196, v220
    v_mul_f32 v222, -v196, v222
    v_mul_f32 v221, v197, v221
    v_mul_f32 v223, -v197, v223
    v_mul_f32 v224, v198, v224
    v_mul_f32 v226, -v198, v226
    v_mul_f32 v225, v199, v225
    v_mul_f32 v227, -v199, v227
    v_mul_f32 v228, v200, v228
    v_mul_f32 v230, -v200, v230
    v_mul_f32 v229, v201, v229
    v_mul_f32 v231, -v201, v231
    v_mul_f32 v232, v202, v232
    v_mul_f32 v234, -v202, v234
    v_mul_f32 v233, v203, v233
    v_mul_f32 v235, -v203, v235
    v_mul_f32 v236, v204, v236
    v_mul_f32 v237, v204, v237
    s_mov_b32 s58, 0
    s_mov_b32 s59, 0
    v_add_u32 v172, s58, v238
    v_add_u32 v176, s59, v239
    v_xor_b32 v173, 64, v172
    v_add_u32 v178, s59, v240
    v_xor_b32 v174, 2048, v172
    v_xor_b32 v175, 2048, v173
    v_xor_b32 v177, 64, v176
    s_lshl_b32 s40, s3, 3
    s_add_u32 s40, s40, s6
    s_lshl_b32 s40, s40, 2
    v_mov_b32 v3, s40
    s_mov_b32 s72, 0
Lw_34:
    ds_read_b32 v250, v253 offset:80
    s_add_u32 s72, s72, 1
    s_cmp_ge_u32 s72, 524288
    s_waitcnt lgkmcnt(0)
    v_cmp_gt_u32 vcc, 1, v250
    s_cbranch_vccz Lwd_35
    s_cbranch_scc1 Lwd_35
    s_sleep 1
    s_branch Lw_34
Lwd_35:
    ds_read_b32 v72, v5 offset:0
    ds_read_b32 v74, v5 offset:4
    ds_read_b32 v76, v5 offset:128
    ds_read_b32 v78, v5 offset:132
    ds_read_b32 v80, v5 offset:256
    ds_read_b32 v82, v5 offset:260
    ds_read_b32 v84, v5 offset:384
    ds_read_b32 v86, v5 offset:388
    ds_read_b32 v96, v244 offset:512
    v_mov_b32 v6, 155528
    s_waitcnt lgkmcnt(0)
    v_fmac_f32 v73, v34, v72
    v_fmac_f32 v75, v34, v74
    v_fmac_f32 v77, v38, v76
    v_fmac_f32 v79, v38, v78
    v_fmac_f32 v81, v42, v80
    v_fmac_f32 v83, v42, v82
    v_fmac_f32 v85, v46, v84
    v_fmac_f32 v87, v46, v86
    v_fmac_f32 v73, v35, v74
    v_fma_f32 v75, -v35, v72, v75
    v_fmac_f32 v77, v39, v78
    v_fma_f32 v79, -v39, v76, v79
    v_fmac_f32 v81, v43, v82
    v_fma_f32 v83, -v43, v80, v83
    v_fmac_f32 v85, v47, v86
    v_fma_f32 v87, -v47, v84, v87
    s_mov_b32 s72, 0
Lw_36:
    ds_read_b32 v250, v253 offset:64
    s_add_u32 s72, s72, 1
    s_cmp_ge_u32 s72, 524288
    s_waitcnt lgkmcnt(0)
    v_cmp_gt_u32 vcc, 1, v250
    s_cbranch_vccz Lwd_37
    s_cbranch_scc1 Lwd_37
    s_branch Lw_36
Lwd_37:
    s_setprio 3
    ds_read_b64 v[56:57], v9 offset:0
    ds_read_b64 v[60:61], v9 offset:128
    ds_read_b64 v[64:65], v9 offset:256
    ds_read_b64 v[68:69], v9 offset:384
    ds_read_b32 v97, v245 offset:512
    ds_read_b64 v[10:11], v6
    s_waitcnt lgkmcnt(0)
    v_readfirstlane_b32 s43, v11
    v_pk_fma_f32 v[72:73], v[56:57], v[220:221], v[72:73] op_sel:[0,0,0] op_sel_hi:[0,1,1]
    v_pk_fma_f32 v[74:75], v[56:57], v[220:221], v[74:75] op_sel:[1,0,0] op_sel_hi:[1,1,1]
    v_pk_fma_f32 v[76:77], v[60:61], v[224:225], v[76:77] op_sel:[0,0,0] op_sel_hi:[0,1,1]
    v_pk_fma_f32 v[78:79], v[60:61], v[224:225], v[78:79] op_sel:[1,0,0] op_sel_hi:[1,1,1]
    s_cmp_eq_u32 s43, 1
    v_pk_fma_f32 v[72:73], v[56:57], v[222:223], v[72:73] op_sel:[1,0,0] op_sel_hi:[1,1,1] neg_lo:[1,0,0] neg_hi:[1,0,0]
    v_pk_fma_f32 v[74:75], v[56:57], v[222:223], v[74:75] op_sel:[0,0,0] op_sel_hi:[0,1,1]
    v_pk_fma_f32 v[76:77], v[60:61], v[226:227], v[76:77] op_sel:[1,0,0] op_sel_hi:[1,1,1] neg_lo:[1,0,0] neg_hi:[1,0,0]
    v_pk_fma_f32 v[78:79], v[60:61], v[226:227], v[78:79] op_sel:[0,0,0] op_sel_hi:[0,1,1]
    v_pk_fma_f32 v[100:101], v[12:13], v[72:73], v[100:101] op_sel:[0,0,0] op_sel_hi:[0,1,1]
    v_pk_fma_f32 v[108:109], v[12:13], v[74:75], v[108:109] op_sel:[0,0,0] op_sel_hi:[0,1,1]
    v_pk_fma_f32 v[116:117], v[16:17], v[76:77], v[116:117] op_sel:[0,0,0] op_sel_hi:[0,1,1]
    v_pk_fma_f32 v[124:125], v[16:17], v[78:79], v[124:125] op_sel:[0,0,0] op_sel_hi:[0,1,1]
    v_pk_fma_f32 v[100:101], v[12:13], v[74:75], v[100:101] op_sel:[1,0,0] op_sel_hi:[1,1,1]
    v_pk_fma_f32 v[108:109], v[12:13], v[72:73], v[108:109] op_sel:[1,0,0] op_sel_hi:[1,1,1] neg_lo:[1,0,0] neg_hi:[1,0,0]
    v_pk_fma_f32 v[116:117], v[16:17], v[78:79], v[116:117] op_sel:[1,0,0] op_sel_hi:[1,1,1]
    v_pk_fma_f32 v[124:125], v[16:17], v[76:77], v[124:125] op_sel:[1,0,0] op_sel_hi:[1,1,1] neg_lo:[1,0,0] neg_hi:[1,0,0]
    v_pk_fma_f32 v[102:103], v[12:13], v[100:101], v[102:103] op_sel:[0,0,0] op_sel_hi:[0,1,1]
    v_pk_fma_f32 v[110:111], v[12:13], v[108:109], v[110:111] op_sel:[0,0,0] op_sel_hi:[0,1,1]
    v_pk_fma_f32 v[118:119], v[16:17], v[116:117], v[118:119] op_sel:[0,0,0] op_sel_hi:[0,1,1]
    v_pk_fma_f32 v[126:127], v[16:17], v[124:125], v[126:127] op_sel:[0,0,0] op_sel_hi:[0,1,1]
    v_pk_fma_f32 v[102:103], v[12:13], v[108:109], v[102:103] op_sel:[1,0,0] op_sel_hi:[1,1,1]
    v_pk_fma_f32 v[110:111], v[12:13], v[100:101], v[110:111] op_sel:[1,0,0] op_sel_hi:[1,1,1] neg_lo:[1,0,0] neg_hi:[1,0,0]
    v_pk_fma_f32 v[118:119], v[16:17], v[124:125], v[118:119] op_sel:[1,0,0] op_sel_hi:[1,1,1]
    v_pk_fma_f32 v[126:127], v[16:17], v[116:117], v[126:127] op_sel:[1,0,0] op_sel_hi:[1,1,1] neg_lo:[1,0,0] neg_hi:[1,0,0]
    v_pk_fma_f32 v[104:105], v[12:13], v[102:103], v[104:105] op_sel:[0,0,0] op_sel_hi:[0,1,1]
    v_pk_fma_f32 v[112:113], v[12:13], v[110:111], v[112:113] op_sel:[0,0,0] op_sel_hi:[0,1,1]
    v_pk_fma_f32 v[120:121], v[16:17], v[118:119], v[120:121] op_sel:[0,0,0] op_sel_hi:[0,1,1]
    v_pk_fma_f32 v[128:129], v[16:17], v[126:127], v[128:129] op_sel:[0,0,0] op_sel_hi:[0,1,1]
    v_pk_fma_f32 v[104:105], v[12:13], v[110:111], v[104:105] op_sel:[1,0,0] op_sel_hi:[1,1,1]
    v_pk_fma_f32 v[112:113], v[12:13], v[102:103], v[112:113] op_sel:[1,0,0] op_sel_hi:[1,1,1] neg_lo:[1,0,0] neg_hi:[1,0,0]
    v_pk_fma_f32 v[120:121], v[16:17], v[126:127], v[120:121] op_sel:[1,0,0] op_sel_hi:[1,1,1]
    v_pk_fma_f32 v[128:129], v[16:17], v[118:119], v[128:129] op_sel:[1,0,0] op_sel_hi:[1,1,1] neg_lo:[1,0,0] neg_hi:[1,0,0]
    v_pk_fma_f32 v[106:107], v[12:13], v[104:105], v[106:107] op_sel:[0,0,0] op_sel_hi:[0,1,1]
    v_pk_fma_f32 v[114:115], v[12:13], v[112:113], v[114:115] op_sel:[0,0,0] op_sel_hi:[0,1,1]
    v_pk_fma_f32 v[122:123], v[16:17], v[120:121], v[122:123] op_sel:[0,0,0] op_sel_hi:[0,1,1]
    v_pk_fma_f32 v[130:131], v[16:17], v[128:129], v[130:131] op_sel:[0,0,0] op_sel_hi:[0,1,1]
    v_pk_fma_f32 v[106:107], v[12:13], v[112:113], v[106:107] op_sel:[1,0,0] op_sel_hi:[1,1,1]
    v_pk_fma_f32 v[114:115], v[12:13], v[104:105], v[114:115] op_sel:[1,0,0] op_sel_hi:[1,1,1] neg_lo:[1,0,0] neg_hi:[1,0,0]
    v_pk_fma_f32 v[122:123], v[16:17], v[128:129], v[122:123] op_sel:[1,0,0] op_sel_hi:[1,1,1]
    v_pk_fma_f32 v[130:131], v[16:17], v[120:121], v[130:131] op_sel:[1,0,0] op_sel_hi:[1,1,1] neg_lo:[1,0,0] neg_hi:[1,0,0]
    v_cvt_pk_bf16_f32 v100, v100, v102
    v_cvt_pk_bf16_f32 v102, v101, v103
    v_cvt_pk_bf16_f32 v101, v104, v106
    v_cvt_pk_bf16_f32 v103, v105, v107
    v_cvt_pk_bf16_f32 v108, v108, v110
    v_cvt_pk_bf16_f32 v110, v109, v111
    v_cvt_pk_bf16_f32 v109, v112, v114
    v_cvt_pk_bf16_f32 v111, v113, v115
    v_cvt_pk_bf16_f32 v116, v116, v118
    v_cvt_pk_bf16_f32 v118, v117, v119
    v_cvt_pk_bf16_f32 v117, v120, v122
    v_cvt_pk_bf16_f32 v119, v121, v123
    v_cvt_pk_bf16_f32 v124, v124, v126
    v_cvt_pk_bf16_f32 v126, v125, v127
    v_cvt_pk_bf16_f32 v125, v128, v130
    v_cvt_pk_bf16_f32 v127, v129, v131
    s_cbranch_scc1 Lf_38
    buffer_store_dwordx4 v[100:103], v7, s[44:47], s57 offen offset:0 sc1
    buffer_store_dwordx4 v[108:111], v7, s[44:47], s55 offen offset:0 sc1
    buffer_store_dwordx4 v[116:119], v7, s[44:47], s57 offen offset:1024 sc1
    buffer_store_dwordx4 v[124:127], v7, s[44:47], s55 offen offset:1024 sc1
    s_branch Lj_39
Lf_38:
    buffer_store_dwordx4 v[100:103], v7, s[44:47], s57 offen offset:0
    buffer_store_dwordx4 v[108:111], v7, s[44:47], s55 offen offset:0
    buffer_store_dwordx4 v[116:119], v7, s[44:47], s57 offen offset:1024
    buffer_store_dwordx4 v[124:127], v7, s[44:47], s55 offen offset:1024
Lj_39:
    v_pk_fma_f32 v[80:81], v[64:65], v[228:229], v[80:81] op_sel:[0,0,0] op_sel_hi:[0,1,1]
    v_pk_fma_f32 v[82:83], v[64:65], v[228:229], v[82:83] op_sel:[1,0,0] op_sel_hi:[1,1,1]
    v_fmac_f32 v96, v236, v97
    v_pk_fma_f32 v[84:85], v[68:69], v[232:233], v[84:85] op_sel:[0,0,0] op_sel_hi:[0,1,1]
    v_pk_fma_f32 v[86:87], v[68:69], v[232:233], v[86:87] op_sel:[1,0,0] op_sel_hi:[1,1,1]
    v_fmac_f32_dpp v96, v97, v237 row_ror:8 row_mask:0xf bank_mask:0xf
    v_pk_fma_f32 v[80:81], v[64:65], v[230:231], v[80:81] op_sel:[1,0,0] op_sel_hi:[1,1,1] neg_lo:[1,0,0] neg_hi:[1,0,0]
    v_pk_fma_f32 v[82:83], v[64:65], v[230:231], v[82:83] op_sel:[0,0,0] op_sel_hi:[0,1,1]
    v_fmac_f32 v164, v28, v96
    v_pk_fma_f32 v[84:85], v[68:69], v[234:235], v[84:85] op_sel:[1,0,0] op_sel_hi:[1,1,1] neg_lo:[1,0,0] neg_hi:[1,0,0]
    v_pk_fma_f32 v[86:87], v[68:69], v[234:235], v[86:87] op_sel:[0,0,0] op_sel_hi:[0,1,1]
    v_fmac_f32_dpp v164, v96, v52 row_ror:8 row_mask:0xf bank_mask:0xf
    v_pk_fma_f32 v[132:133], v[20:21], v[80:81], v[132:133] op_sel:[0,0,0] op_sel_hi:[0,1,1]
    v_pk_fma_f32 v[140:141], v[20:21], v[82:83], v[140:141] op_sel:[0,0,0] op_sel_hi:[0,1,1]
    v_fmac_f32 v166, v28, v164
    v_pk_fma_f32 v[148:149], v[24:25], v[84:85], v[148:149] op_sel:[0,0,0] op_sel_hi:[0,1,1]
    v_pk_fma_f32 v[156:157], v[24:25], v[86:87], v[156:157] op_sel:[0,0,0] op_sel_hi:[0,1,1]
    v_fmac_f32_dpp v166, v164, v52 row_ror:8 row_mask:0xf bank_mask:0xf
    v_pk_fma_f32 v[132:133], v[20:21], v[82:83], v[132:133] op_sel:[1,0,0] op_sel_hi:[1,1,1]
    v_pk_fma_f32 v[140:141], v[20:21], v[80:81], v[140:141] op_sel:[1,0,0] op_sel_hi:[1,1,1] neg_lo:[1,0,0] neg_hi:[1,0,0]
    v_fmac_f32 v168, v28, v166
    v_pk_fma_f32 v[148:149], v[24:25], v[86:87], v[148:149] op_sel:[1,0,0] op_sel_hi:[1,1,1]
    v_pk_fma_f32 v[156:157], v[24:25], v[84:85], v[156:157] op_sel:[1,0,0] op_sel_hi:[1,1,1] neg_lo:[1,0,0] neg_hi:[1,0,0]
    v_fmac_f32_dpp v168, v166, v52 row_ror:8 row_mask:0xf bank_mask:0xf
    v_pk_fma_f32 v[134:135], v[20:21], v[132:133], v[134:135] op_sel:[0,0,0] op_sel_hi:[0,1,1]
    v_pk_fma_f32 v[142:143], v[20:21], v[140:141], v[142:143] op_sel:[0,0,0] op_sel_hi:[0,1,1]
    v_fmac_f32 v170, v28, v168
    v_pk_fma_f32 v[150:151], v[24:25], v[148:149], v[150:151] op_sel:[0,0,0] op_sel_hi:[0,1,1]
    v_pk_fma_f32 v[158:159], v[24:25], v[156:157], v[158:159] op_sel:[0,0,0] op_sel_hi:[0,1,1]
    v_fmac_f32_dpp v170, v168, v52 row_ror:8 row_mask:0xf bank_mask:0xf
    v_pk_fma_f32 v[134:135], v[20:21], v[140:141], v[134:135] op_sel:[1,0,0] op_sel_hi:[1,1,1]
    v_pk_fma_f32 v[142:143], v[20:21], v[132:133], v[142:143] op_sel:[1,0,0] op_sel_hi:[1,1,1] neg_lo:[1,0,0] neg_hi:[1,0,0]
    v_fmac_f32 v165, v28, v170
    v_pk_fma_f32 v[150:151], v[24:25], v[156:157], v[150:151] op_sel:[1,0,0] op_sel_hi:[1,1,1]
    v_pk_fma_f32 v[158:159], v[24:25], v[148:149], v[158:159] op_sel:[1,0,0] op_sel_hi:[1,1,1] neg_lo:[1,0,0] neg_hi:[1,0,0]
    v_fmac_f32_dpp v165, v170, v52 row_ror:8 row_mask:0xf bank_mask:0xf
    v_pk_fma_f32 v[136:137], v[20:21], v[134:135], v[136:137] op_sel:[0,0,0] op_sel_hi:[0,1,1]
    v_pk_fma_f32 v[144:145], v[20:21], v[142:143], v[144:145] op_sel:[0,0,0] op_sel_hi:[0,1,1]
    v_fmac_f32 v167, v28, v165
    v_pk_fma_f32 v[152:153], v[24:25], v[150:151], v[152:153] op_sel:[0,0,0] op_sel_hi:[0,1,1]
    v_pk_fma_f32 v[160:161], v[24:25], v[158:159], v[160:161] op_sel:[0,0,0] op_sel_hi:[0,1,1]
    v_fmac_f32_dpp v167, v165, v52 row_ror:8 row_mask:0xf bank_mask:0xf
    v_pk_fma_f32 v[136:137], v[20:21], v[142:143], v[136:137] op_sel:[1,0,0] op_sel_hi:[1,1,1]
    v_pk_fma_f32 v[144:145], v[20:21], v[134:135], v[144:145] op_sel:[1,0,0] op_sel_hi:[1,1,1] neg_lo:[1,0,0] neg_hi:[1,0,0]
    v_fmac_f32 v169, v28, v167
    v_pk_fma_f32 v[152:153], v[24:25], v[158:159], v[152:153] op_sel:[1,0,0] op_sel_hi:[1,1,1]
    v_pk_fma_f32 v[160:161], v[24:25], v[150:151], v[160:161] op_sel:[1,0,0] op_sel_hi:[1,1,1] neg_lo:[1,0,0] neg_hi:[1,0,0]
    v_fmac_f32_dpp v169, v167, v52 row_ror:8 row_mask:0xf bank_mask:0xf
    v_pk_fma_f32 v[138:139], v[20:21], v[136:137], v[138:139] op_sel:[0,0,0] op_sel_hi:[0,1,1]
    v_pk_fma_f32 v[146:147], v[20:21], v[144:145], v[146:147] op_sel:[0,0,0] op_sel_hi:[0,1,1]
    v_fmac_f32 v171, v28, v169
    v_pk_fma_f32 v[154:155], v[24:25], v[152:153], v[154:155] op_sel:[0,0,0] op_sel_hi:[0,1,1]
    v_pk_fma_f32 v[162:163], v[24:25], v[160:161], v[162:163] op_sel:[0,0,0] op_sel_hi:[0,1,1]
    v_fmac_f32_dpp v171, v169, v52 row_ror:8 row_mask:0xf bank_mask:0xf
    v_pk_fma_f32 v[138:139], v[20:21], v[144:145], v[138:139] op_sel:[1,0,0] op_sel_hi:[1,1,1]
    v_pk_fma_f32 v[146:147], v[20:21], v[136:137], v[146:147] op_sel:[1,0,0] op_sel_hi:[1,1,1] neg_lo:[1,0,0] neg_hi:[1,0,0]
    v_pk_fma_f32 v[154:155], v[24:25], v[160:161], v[154:155] op_sel:[1,0,0] op_sel_hi:[1,1,1]
    v_pk_fma_f32 v[162:163], v[24:25], v[152:153], v[162:163] op_sel:[1,0,0] op_sel_hi:[1,1,1] neg_lo:[1,0,0] neg_hi:[1,0,0]
    v_cvt_pk_bf16_f32 v132, v132, v134
    v_cvt_pk_bf16_f32 v134, v133, v135
    v_cvt_pk_bf16_f32 v133, v136, v138
    v_cvt_pk_bf16_f32 v135, v137, v139
    v_cvt_pk_bf16_f32 v140, v140, v142
    v_cvt_pk_bf16_f32 v142, v141, v143
    v_cvt_pk_bf16_f32 v141, v144, v146
    v_cvt_pk_bf16_f32 v143, v145, v147
    v_cvt_pk_bf16_f32 v148, v148, v150
    v_cvt_pk_bf16_f32 v150, v149, v151
    v_cvt_pk_bf16_f32 v149, v152, v154
    v_cvt_pk_bf16_f32 v151, v153, v155
    v_cvt_pk_bf16_f32 v156, v156, v158
    v_cvt_pk_bf16_f32 v158, v157, v159
    v_cvt_pk_bf16_f32 v157, v160, v162
    v_cvt_pk_bf16_f32 v159, v161, v163
    v_cvt_pk_bf16_f32 v164, v164, v166
    v_cvt_pk_bf16_f32 v166, v165, v167
    v_cvt_pk_bf16_f32 v165, v168, v170
    v_cvt_pk_bf16_f32 v167, v169, v171
    s_cbranch_scc1 Lf_40
    buffer_store_dwordx4 v[132:135], v7, s[44:47], s57 offen offset:2048 sc1
    buffer_store_dwordx4 v[140:143], v7, s[44:47], s55 offen offset:2048 sc1
    buffer_store_dwordx4 v[148:151], v7, s[44:47], s57 offen offset:3072 sc1
    buffer_store_dwordx4 v[156:159], v7, s[44:47], s55 offen offset:3072 sc1
    buffer_store_dwordx4 v[164:167], v8, s[44:47], s56 offen sc1
    s_waitcnt vmcnt(0)
    s_mov_b64 exec, 1
    buffer_store_dword v10, v3, s[48:51], 0 offen sc1
    s_mov_b64 exec, -1
    s_branch Lj_41
Lf_40:
    buffer_store_dwordx4 v[132:135], v7, s[44:47], s57 offen offset:2048
    buffer_store_dwordx4 v[140:143], v7, s[44:47], s55 offen offset:2048
    buffer_store_dwordx4 v[148:151], v7, s[44:47], s57 offen offset:3072
    buffer_store_dwordx4 v[156:159], v7, s[44:47], s55 offen offset:3072
    buffer_store_dwordx4 v[164:167], v8, s[44:47], s56 offen
    s_waitcnt vmcnt(0)
    s_mov_b64 exec, 1
    buffer_store_dword v10, v3, s[48:51], 0 offen
    s_mov_b64 exec, -1
Lj_41:
    s_mov_b32 s72, 0
Lw_42:
    ds_read_b32 v250, v253 offset:32
    s_add_u32 s72, s72, 1
    s_cmp_ge_u32 s72, 524288
    s_waitcnt lgkmcnt(0)
    v_cmp_gt_u32 vcc, 1, v250
    s_cbranch_vccz Lwd_43
    s_cbranch_scc1 Lwd_43
    s_branch Lw_42
Lwd_43:
    s_mul_i32 s41, s3, 5120
    v_lshlrev_b32 v229, 4, v0
    v_add_u32 v229, s41, v229
    ds_read_b128 v[12:15], v229 offset:0
    ds_read_b128 v[16:19], v229 offset:1024
    ds_read_b128 v[20:23], v229 offset:2048
    ds_read_b128 v[24:27], v229 offset:3072
    ds_read_b128 v[28:31], v229 offset:4096
    s_mov_b32 s52, s26
    s_mov_b32 s53, s27
    s_mov_b32 s54, 9437184
    s_mov_b32 s55, 0x20000
    s_mul_i32 s40, s64, 4608
    s_mul_i32 s41, s4, 2304
    s_add_u32 s40, s40, s41
    s_lshl_b32 s41, s65, 2
    s_add_u32 s40, s40, s41
    s_movk_i32 s41, 18432
    s_waitcnt lgkmcnt(0)
    s_mov_b64 exec, 1
    ds_write_b32 v242, v243 offset:0
    s_mov_b64 exec, -1
    v_mul_lo_u32 v229, v2, s41
    v_lshl_add_u32 v229, v1, 2, v229
    v_add_u32 v220, 0, v229
    v_add_u32 v221, 4608, v229
    v_add_u32 v222, 9216, v229
    v_add_u32 v223, 13824, v229
    v_add_u32 v224, 73728, v229
    v_add_u32 v225, 78336, v229
    v_add_u32 v226, 82944, v229
    v_add_u32 v227, 87552, v229
    s_lshl_b32 s41, s60, 11
    s_add_u32 s41, s41, 145664
    v_lshlrev_b32 v228, 4, v0
    v_add_u32 v228, s41, v228
    v_lshlrev_b32 v180, 16, v12
    v_and_b32 v181, 0xffff0000, v12
    v_lshlrev_b32 v182, 16, v13
    v_and_b32 v183, 0xffff0000, v13
    v_lshlrev_b32 v184, 16, v14
    v_and_b32 v185, 0xffff0000, v14
    v_lshlrev_b32 v186, 16, v15
    v_and_b32 v187, 0xffff0000, v15
    v_lshlrev_b32 v188, 16, v16
    v_and_b32 v189, 0xffff0000, v16
    v_lshlrev_b32 v190, 16, v17
    v_and_b32 v191, 0xffff0000, v17
    v_lshlrev_b32 v192, 16, v18
    v_and_b32 v193, 0xffff0000, v18
    v_lshlrev_b32 v194, 16, v19
    v_and_b32 v195, 0xffff0000, v19
    v_lshlrev_b32 v196, 16, v20
    v_and_b32 v197, 0xffff0000, v20
    v_lshlrev_b32 v198, 16, v21
    v_and_b32 v199, 0xffff0000, v21
    v_lshlrev_b32 v200, 16, v22
    v_and_b32 v201, 0xffff0000, v22
    v_lshlrev_b32 v202, 16, v23
    v_and_b32 v203, 0xffff0000, v23
    v_lshlrev_b32 v204, 16, v24
    v_and_b32 v205, 0xffff0000, v24
    v_lshlrev_b32 v206, 16, v25
    v_and_b32 v207, 0xffff0000, v25
    v_lshlrev_b32 v208, 16, v26
    v_and_b32 v209, 0xffff0000, v26
    v_lshlrev_b32 v210, 16, v27
    v_and_b32 v211, 0xffff0000, v27
    v_lshlrev_b32 v212, 16, v28
    v_and_b32 v213, 0xffff0000, v28
    v_lshlrev_b32 v214, 16, v29
    v_and_b32 v215, 0xffff0000, v29
    v_lshlrev_b32 v216, 16, v30
    v_and_b32 v217, 0xffff0000, v30
    v_lshlrev_b32 v218, 16, v31
    v_and_b32 v219, 0xffff0000, v31
    s_cmp_eq_u32 s61, 0
    s_cbranch_scc1 Lz_44
    v_mov_b32 v212, 0
    v_mov_b32 v213, 0
    v_mov_b32 v214, 0
    v_mov_b32 v215, 0
    v_mov_b32 v216, 0
    v_mov_b32 v217, 0
    v_mov_b32 v218, 0
    v_mov_b32 v219, 0
Lz_44:
    s_mov_b32 s42, 0
    s_barrier
    ds_read_b64_tr_b16 v[12:13], v172 offset:0
    ds_read_b64_tr_b16 v[14:15], v173 offset:0
    ds_read_b128 v[20:23], v176 offset:0
    ds_read_b64_tr_b16 v[16:17], v172 offset:256
    ds_read_b64_tr_b16 v[18:19], v173 offset:256
    ds_read_b128 v[24:27], v176 offset:2048
    ds_read_b128 v[28:31], v176 offset:4096
    ds_read_b128 v[32:35], v176 offset:6144
    ds_read_b128 v[36:39], v178
.p2align 6
L_c2_loop:
    s_waitcnt lgkmcnt(6)
    v_mfma_f32_16x16x32_bf16 v[180:183], v[12:15], v[20:23], v[180:183]
    ds_read_b64_tr_b16 v[40:41], v174 offset:0
    ds_read_b64_tr_b16 v[42:43], v175 offset:0
    s_waitcnt lgkmcnt(6)
    v_mfma_f32_16x16x32_bf16 v[184:187], v[16:19], v[20:23], v[184:187]
    ds_read_b128 v[48:51], v177 offset:0
    ds_read_b64_tr_b16 v[44:45], v174 offset:256
    s_waitcnt lgkmcnt(7)
    v_mfma_f32_16x16x32_bf16 v[188:191], v[12:15], v[24:27], v[188:191]
    ds_read_b64_tr_b16 v[46:47], v175 offset:256
    ds_read_b128 v[52:55], v177 offset:2048
    v_mfma_f32_16x16x32_bf16 v[192:195], v[16:19], v[24:27], v[192:195]
    ds_read_b128 v[56:59], v177 offset:4096
    ds_read_b128 v[60:63], v177 offset:6144
    s_waitcnt lgkmcnt(10)
    v_mfma_f32_16x16x32_bf16 v[196:199], v[12:15], v[28:31], v[196:199]
    s_add_u32 s58, s58, 8192
    s_and_b32 s58, s58, 32767
    v_mfma_f32_16x16x32_bf16 v[200:203], v[16:19], v[28:31], v[200:203]
    s_add_u32 s59, s59, 18432
    s_cmp_ge_u32 s59, 110592
    s_waitcnt lgkmcnt(9)
    v_mfma_f32_16x16x32_bf16 v[204:207], v[12:15], v[32:35], v[204:207]
    s_cselect_b32 s59, 0, s59
    v_add_u32 v172, s58, v238
    v_mfma_f32_16x16x32_bf16 v[208:211], v[16:19], v[32:35], v[208:211]
    v_add_u32 v176, s59, v239
    v_xor_b32 v173, 64, v172
    s_waitcnt lgkmcnt(8)
    v_mfma_f32_16x16x32_bf16 v[212:215], v[12:15], v[36:39], v[212:215]
    v_add_u32 v178, s59, v240
    s_add_u32 s42, s42, 1
    v_mfma_f32_16x16x32_bf16 v[216:219], v[16:19], v[36:39], v[216:219]
    s_cmp_lt_u32 s42, 18
    s_cbranch_scc0 L_c2_tail
    s_waitcnt lgkmcnt(5)
    v_mfma_f32_16x16x32_bf16 v[180:183], v[40:43], v[48:51], v[180:183]
    s_waitcnt lgkmcnt(3)
    v_mfma_f32_16x16x32_bf16 v[184:187], v[44:47], v[48:51], v[184:187]
    s_waitcnt lgkmcnt(0)
    s_barrier
    v_mfma_f32_16x16x32_bf16 v[188:191], v[40:43], v[52:55], v[188:191]
    ds_read_b64_tr_b16 v[12:13], v172 offset:0
    ds_read_b64_tr_b16 v[14:15], v173 offset:0
    v_mfma_f32_16x16x32_bf16 v[192:195], v[44:47], v[52:55], v[192:195]
    ds_read_b128 v[20:23], v176 offset:0
    ds_read_b64_tr_b16 v[16:17], v172 offset:256
    v_mfma_f32_16x16x32_bf16 v[196:199], v[40:43], v[56:59], v[196:199]
    ds_read_b64_tr_b16 v[18:19], v173 offset:256
    ds_read_b128 v[24:27], v176 offset:2048
    v_mfma_f32_16x16x32_bf16 v[200:203], v[44:47], v[56:59], v[200:203]
    ds_read_b128 v[28:31], v176 offset:4096
    ds_read_b128 v[32:35], v176 offset:6144
    v_mfma_f32_16x16x32_bf16 v[204:207], v[40:43], v[60:63], v[204:207]
    ds_read_b128 v[36:39], v178
    v_xor_b32 v174, 2048, v172
    v_mfma_f32_16x16x32_bf16 v[208:211], v[44:47], v[60:63], v[208:211]
    v_xor_b32 v175, 2048, v173
    v_xor_b32 v177, 64, v176
    s_branch L_c2_loop
L_c2_tail:
    s_waitcnt lgkmcnt(5)
    v_mfma_f32_16x16x32_bf16 v[180:183], v[40:43], v[48:51], v[180:183]
    s_waitcnt lgkmcnt(3)
    v_mfma_f32_16x16x32_bf16 v[184:187], v[44:47], v[48:51], v[184:187]
    s_waitcnt lgkmcnt(2)
    v_mfma_f32_16x16x32_bf16 v[188:191], v[40:43], v[52:55], v[188:191]
    v_mfma_f32_16x16x32_bf16 v[192:195], v[44:47], v[52:55], v[192:195]
    s_waitcnt lgkmcnt(1)
    v_mfma_f32_16x16x32_bf16 v[196:199], v[40:43], v[56:59], v[196:199]
    v_mfma_f32_16x16x32_bf16 v[200:203], v[44:47], v[56:59], v[200:203]
    s_waitcnt lgkmcnt(0)
    v_mfma_f32_16x16x32_bf16 v[204:207], v[40:43], v[60:63], v[204:207]
    v_mfma_f32_16x16x32_bf16 v[208:211], v[44:47], v[60:63], v[208:211]
    s_cmp_eq_u32 s61, 0
    s_cbranch_scc1 L_nosend
    ds_write_b128 v228, v[212:215]
    ds_write_b128 v228, v[216:219] offset:1024
    v_mov_b32 v243, 50
    s_mov_b64 exec, 1
    ds_write_b32 v242, v243 offset:32
    s_mov_b64 exec, -1
L_nosend:
    s_nop 4
    buffer_store_dword v180, v220, s[52:55], s40 offen offset:0 sc1
    buffer_store_dword v181, v221, s[52:55], s40 offen offset:0 sc1
    buffer_store_dword v182, v222, s[52:55], s40 offen offset:0 sc1
    buffer_store_dword v183, v223, s[52:55], s40 offen offset:0 sc1
    buffer_store_dword v184, v224, s[52:55], s40 offen offset:0 sc1
    buffer_store_dword v185, v225, s[52:55], s40 offen offset:0 sc1
    buffer_store_dword v186, v226, s[52:55], s40 offen offset:0 sc1
    buffer_store_dword v187, v227, s[52:55], s40 offen offset:0 sc1
    buffer_store_dword v188, v220, s[52:55], s40 offen offset:64 sc1
    buffer_store_dword v189, v221, s[52:55], s40 offen offset:64 sc1
    buffer_store_dword v190, v222, s[52:55], s40 offen offset:64 sc1
    buffer_store_dword v191, v223, s[52:55], s40 offen offset:64 sc1
    buffer_store_dword v192, v224, s[52:55], s40 offen offset:64 sc1
    buffer_store_dword v193, v225, s[52:55], s40 offen offset:64 sc1
    buffer_store_dword v194, v226, s[52:55], s40 offen offset:64 sc1
    buffer_store_dword v195, v227, s[52:55], s40 offen offset:64 sc1
    buffer_store_dword v196, v220, s[52:55], s40 offen offset:128 sc1
    buffer_store_dword v197, v221, s[52:55], s40 offen offset:128 sc1
    buffer_store_dword v198, v222, s[52:55], s40 offen offset:128 sc1
    buffer_store_dword v199, v223, s[52:55], s40 offen offset:128 sc1
    buffer_store_dword v200, v224, s[52:55], s40 offen offset:128 sc1
    buffer_store_dword v201, v225, s[52:55], s40 offen offset:128 sc1
    buffer_store_dword v202, v226, s[52:55], s40 offen offset:128 sc1
    buffer_store_dword v203, v227, s[52:55], s40 offen offset:128 sc1
    buffer_store_dword v204, v220, s[52:55], s40 offen offset:192 sc1
    buffer_store_dword v205, v221, s[52:55], s40 offen offset:192 sc1
    buffer_store_dword v206, v222, s[52:55], s40 offen offset:192 sc1
    buffer_store_dword v207, v223, s[52:55], s40 offen offset:192 sc1
    buffer_store_dword v208, v224, s[52:55], s40 offen offset:192 sc1
    buffer_store_dword v209, v225, s[52:55], s40 offen offset:192 sc1
    buffer_store_dword v210, v226, s[52:55], s40 offen offset:192 sc1
    buffer_store_dword v211, v227, s[52:55], s40 offen offset:192 sc1
    s_cmp_eq_u32 s61, 1
    s_cbranch_scc1 L_skip0
    s_mov_b32 s72, 0
Lw_45:
    ds_read_b32 v250, v242 offset:40
    s_add_u32 s72, s72, 1
    s_cmp_ge_u32 s72, 524288
    s_waitcnt lgkmcnt(0)
    v_cmp_gt_u32 vcc, 50, v250
    s_cbranch_vccz Lwd_46
    s_cbranch_scc1 Lwd_46
    s_branch Lw_45
Lwd_46:
    ds_read_b128 v[16:19], v228
    ds_read_b128 v[20:23], v228 offset:1024
    s_waitcnt lgkmcnt(0)
    v_add_f32 v212, v212, v16
    v_add_f32 v213, v213, v17
    v_add_f32 v214, v214, v18
    v_add_f32 v215, v215, v19
    v_add_f32 v216, v216, v20
    v_add_f32 v217, v217, v21
    v_add_f32 v218, v218, v22
    v_add_f32 v219, v219, v23
    buffer_store_dword v212, v220, s[52:55], s40 offen offset:256 sc1
    buffer_store_dword v213, v221, s[52:55], s40 offen offset:256 sc1
    buffer_store_dword v214, v222, s[52:55], s40 offen offset:256 sc1
    buffer_store_dword v215, v223, s[52:55], s40 offen offset:256 sc1
    buffer_store_dword v216, v224, s[52:55], s40 offen offset:256 sc1
    buffer_store_dword v217, v225, s[52:55], s40 offen offset:256 sc1
    buffer_store_dword v218, v226, s[52:55], s40 offen offset:256 sc1
    buffer_store_dword v219, v227, s[52:55], s40 offen offset:256 sc1
L_skip0:
    s_endpgm
L_end:
    s_endpgm
L_codeend:
.section .rodata,"a"
.p2align 6
.amdhsa_kernel concat_heads__ssm_conv_s5__ssm_conv_s5__prompt_kernel
  .amdhsa_next_free_vgpr 256
  .amdhsa_next_free_sgpr 102
  .amdhsa_accum_offset 256
  .amdhsa_group_segment_fixed_size 0
  .amdhsa_kernarg_size 168
  .amdhsa_user_sgpr_count 2
  .amdhsa_user_sgpr_kernarg_segment_ptr 1
  .amdhsa_system_sgpr_workgroup_id_x 1
  .amdhsa_float_denorm_mode_32 3
  .amdhsa_float_denorm_mode_16_64 3
.end_amdhsa_kernel
```
